```python
import torch

def _softmax(x, axis=-1):
    return torch.softmax(x, dim=axis)
def _gelu(x):
    return torch.nn.functional.gelu(x, approximate="tanh")
def _silu(x):
    return torch.nn.functional.silu(x)
def _sigmoid(x):
    return torch.sigmoid(x)
def _layernorm(x, axis=-1, eps=1e-5):
    m = x.mean(dim=axis, keepdim=True)
    v = x.var(dim=axis, keepdim=True, unbiased=False)
    return (x - m) / torch.sqrt(v + eps)
def _scatter_add(tgt, idx, src, axis=0):
    return tgt.clone().index_add_(axis, idx, src)
def _segment_sum(src, seg, n):
    out = torch.zeros((n,) + src.shape[1:], dtype=src.dtype)
    return out.index_add_(0, seg, src)
def _pad(x, pw):
    flat = tuple(v for pair in reversed(pw) for v in pair)
    return torch.nn.functional.pad(x, flat)

kernel_name = 'interleave_layers__gqa_block_cached__mha_block_cached__decode'

def setup_inputs():

    _w = (lambda a: (lambda t: t.to(torch.bfloat16) if t.is_floating_point() else t)(torch.as_tensor(a)))
    def _A_setup():
        B, Sq, D = 8, 1, 512
        Hq, Hkv, Sk, Dh = 32, 8, 4096, 128
        assert Hq % Hkv == 0, (Hq, Hkv)
        return {
            "x": _w((lambda *s: torch.randn(*s, dtype=torch.bfloat16) * 0.1)(B, Sq, D)),
            "k_cache": _w((lambda *s: torch.randn(*s, dtype=torch.bfloat16) * 0.8)(B, Hkv, Sk, Dh)),
            "v_cache": _w((lambda *s: torch.randn(*s, dtype=torch.bfloat16) * 6.4)(B, Hkv, Sk, Dh)),
            "wq": _w((lambda *s: torch.randn(*s, dtype=torch.bfloat16) * 0.8)(D, Hq * Dh) * (D ** -0.5)),
            "wo": _w((lambda *s: torch.randn(*s, dtype=torch.bfloat16) * 6.4)(Hq * Dh, D) * ((Hq * Dh) ** -0.5)),
        }
    _A_in = _A_setup()

    def _B_setup():
        B, Sq, D = 8, 1, 512
        H, Sk, Dh = 32, 4096, 128
        return {
            "x": _w((lambda *s: torch.randn(*s, dtype=torch.bfloat16) * 0.1)(B, Sq, D)),
            "k_cache": _w((lambda *s: torch.randn(*s, dtype=torch.bfloat16) * 1.6)(B, H, Sk, Dh)),
            "v_cache": _w((lambda *s: torch.randn(*s, dtype=torch.bfloat16) * 3.2)(B, H, Sk, Dh)),
            "wq": _w((lambda *s: torch.randn(*s, dtype=torch.bfloat16) * 1.6)(D, H * Dh) * (D ** -0.5)),
            "wo": _w((lambda *s: torch.randn(*s, dtype=torch.bfloat16) * 3.2)(H * Dh, D) * ((H * Dh) ** -0.5)),
        }
    _B_in = _B_setup()

    return {
        "A_x": _A_in["x"],
        "A_k_cache": _A_in["k_cache"],
        "A_v_cache": _A_in["v_cache"],
        "A_wq": _A_in["wq"],
        "A_wo": _A_in["wo"],
        "B_x": _B_in["x"],
        "B_k_cache": _B_in["k_cache"],
        "B_v_cache": _B_in["v_cache"],
        "B_wq": _B_in["wq"],
        "B_wo": _B_in["wo"],
    }

def reference(A_x, A_k_cache, A_v_cache, A_wq, A_wo, B_x, B_k_cache, B_v_cache, B_wq, B_wo):
    def _A_ref(x, k_cache, v_cache, wq, wo):
        B, Sq, D = x.shape
        Hq, Dh = 32, 128
        Hkv = k_cache.shape[1]
        rep = Hq // Hkv
        q = (lambda x, *d: x.permute(*d))((x @ wq).reshape(B, Sq, Hq, Dh), 0, 2, 1, 3)
        k = (lambda x, n, axis: torch.repeat_interleave(x, n, dim=axis))(k_cache, rep, axis=1)
        v = (lambda x, n, axis: torch.repeat_interleave(x, n, dim=axis))(v_cache, rep, axis=1)
        scores = torch.einsum("bhqd,bhkd->bhqk", q, k) * (Dh ** -0.5)
        p = _softmax(scores, axis=-1)
        o = torch.einsum("bhqk,bhkd->bhqd", p, v)
        return (lambda x, *d: x.permute(*d))(o, 0, 2, 1, 3).reshape(B, Sq, Hq * Dh) @ wo

    def _B_ref(x, k_cache, v_cache, wq, wo):
        B, Sq, D = x.shape
        H, Dh = 32, 128
        q = (lambda x, *d: x.permute(*d))((x @ wq).reshape(B, Sq, H, Dh), 0, 2, 1, 3)
        scores = torch.einsum("bhqd,bhkd->bhqk", q, k_cache) * (Dh ** -0.5)
        p = _softmax(scores, axis=-1)
        o = torch.einsum("bhqk,bhkd->bhqd", p, v_cache)
        return (lambda x, *d: x.permute(*d))(o, 0, 2, 1, 3).reshape(B, Sq, H * Dh) @ wo

    x = A_x
    x = x + _A_ref(_layernorm(x, axis=-1), A_k_cache, A_v_cache, A_wq, A_wo)
    x = x + _B_ref(_layernorm(x, axis=-1), B_k_cache, B_v_cache, B_wq, B_wo)
    x = x + _A_ref(_layernorm(x, axis=-1), A_k_cache, A_v_cache, A_wq, A_wo)
    x = x + _B_ref(_layernorm(x, axis=-1), B_k_cache, B_v_cache, B_wq, B_wo)
    return x
```

```asm
; @launch grid=(256,1,1) block=(512,1,1) lds=139264
.amdgcn_target "amdgcn-amd-amdhsa--gfx950"
.text
.globl interleave_layers__gqa_block_cached__mha_block_cached__decode_kernel
.p2align 8
.type interleave_layers__gqa_block_cached__mha_block_cached__decode_kernel,@function
interleave_layers__gqa_block_cached__mha_block_cached__decode_kernel:
    s_cmp_ge_u32 s2, 256
    s_cbranch_scc1 .Lend
    s_load_dwordx16 s[76:91], s[0:1], 0
    s_load_dwordx8 s[92:99], s[0:1], 64
    s_load_dwordx2 s[100:101], s[0:1], 96
    s_and_b32 s57, s2, 7
    s_lshr_b32 s61, s2, 3
    s_and_b32 s58, s61, 3
    s_lshr_b32 s56, s61, 2
    s_lshl_b32 s59, s57, 2
    s_add_u32 s59, s59, s58
    s_mov_b32 s65, 0x05040100
    s_mov_b32 s66, 0x07060302
    s_mov_b32 s67, 0x3db504f3
    s_mov_b32 s68, 0x3fb8aa3b
    s_mov_b32 s69, 0xffff0000
    v_lshrrev_b32 v4, 6, v0
    s_nop 0
    v_readfirstlane_b32 s60, v4
    v_and_b32 v4, 63, v0
    v_lshlrev_b32 v4, 4, v4
    s_lshl_b32 s61, s60, 15
    v_add_u32 v1, s61, v4
    v_mov_b32 v2, v4
    s_waitcnt lgkmcnt(0)
    s_lshl_b32 s61, s56, 3
    s_add_u32 s61, s61, s57
    s_lshl_b32 s61, s61, 20
    s_lshl_b32 s62, s58, 18
    s_add_u32 s61, s61, s62
    s_add_u32 s78, s78, s61
    s_addc_u32 s79, s79, 0
    s_add_u32 s80, s80, s61
    s_addc_u32 s81, s81, 0
    s_lshl_b32 s61, s56, 5
    s_add_u32 s61, s61, s59
    s_lshl_b32 s61, s61, 20
    s_add_u32 s88, s88, s61
    s_addc_u32 s89, s89, 0
    s_add_u32 s90, s90, s61
    s_addc_u32 s91, s91, 0
    s_mov_b32 s8, s78
    s_and_b32 s9, s79, 0xffff
    s_mov_b32 s10, 0x40000
    s_mov_b32 s11, 0x00020000
    s_mov_b32 s12, s80
    s_and_b32 s13, s81, 0xffff
    s_mov_b32 s14, 0x40000
    s_mov_b32 s15, 0x00020000
    s_mov_b32 s16, s88
    s_and_b32 s17, s89, 0xffff
    s_mov_b32 s18, 0x100000
    s_mov_b32 s19, 0x00020000
    s_mov_b32 s20, s90
    s_and_b32 s21, s91, 0xffff
    s_mov_b32 s22, 0x100000
    s_mov_b32 s23, 0x00020000
    s_mov_b32 s24, s82
    s_and_b32 s25, s83, 0xffff
    s_mov_b32 s26, 0x400000
    s_mov_b32 s27, 0x00020000
    s_mov_b32 s28, s84
    s_and_b32 s29, s85, 0xffff
    s_mov_b32 s30, 0x400000
    s_mov_b32 s31, 0x00020000
    s_mov_b32 s32, s92
    s_and_b32 s33, s93, 0xffff
    s_mov_b32 s34, 0x400000
    s_mov_b32 s35, 0x00020000
    s_mov_b32 s36, s94
    s_and_b32 s37, s95, 0xffff
    s_mov_b32 s38, 0x400000
    s_mov_b32 s39, 0x00020000
    s_mov_b32 s40, s100
    s_and_b32 s41, s101, 0xffff
    s_mov_b32 s42, 0xc00000
    s_mov_b32 s43, 0x00020000
    s_mov_b32 s44, s76
    s_and_b32 s45, s77, 0xffff
    s_mov_b32 s46, 0x2000
    s_mov_b32 s47, 0x00020000
    s_mov_b32 s48, s96
    s_and_b32 s49, s97, 0xffff
    s_mov_b32 s50, 0x2000
    s_mov_b32 s51, 0x00020000
    s_mov_b32 s52, s98
    s_and_b32 s53, s99, 0xffff
    s_mov_b32 s54, 0x100
    s_mov_b32 s55, 0x00020000
    s_lshl_b32 s94, s56, 5
    s_add_u32 s94, s94, s59
    s_lshl_b32 s95, s56, 3
    s_add_u32 s95, s95, s57
    s_mov_b32 s76, s28
    s_mov_b32 s77, s29
    s_mov_b32 s78, s30
    s_mov_b32 s79, 0x00020000
    s_lshl_b32 s99, s60, 12
    s_mul_i32 s101, s60, 12288
    s_add_u32 s101, s101, 40960
    s_mov_b32 s89, 0
    s_mov_b32 s90, 0
    s_mov_b32 s91, 0
    s_branch .Lmain
.LpairB_92:
    v_dot2_f32_bf16 v60, v92, v4, 0
    v_dot2_f32_bf16 v61, v96, v4, 0
    v_dot2_f32_bf16 v62, v100, v4, 0
    v_dot2_f32_bf16 v63, v104, v4, 0
    v_dot2_f32_bf16 v60, v93, v5, v60
    v_dot2_f32_bf16 v61, v97, v5, v61
    v_dot2_f32_bf16 v62, v101, v5, v62
    v_dot2_f32_bf16 v63, v105, v5, v63
    v_dot2_f32_bf16 v60, v94, v6, v60
    v_dot2_f32_bf16 v61, v98, v6, v61
    v_dot2_f32_bf16 v62, v102, v6, v62
    v_dot2_f32_bf16 v63, v106, v6, v63
    v_dot2_f32_bf16 v60, v95, v7, v60
    v_dot2_f32_bf16 v61, v99, v7, v61
    v_dot2_f32_bf16 v62, v103, v7, v62
    v_dot2_f32_bf16 v63, v107, v7, v63
    v_add_f32_dpp v60, v60, v60 row_ror:8 row_mask:0xf bank_mask:0xf
    v_add_f32_dpp v61, v61, v61 row_ror:8 row_mask:0xf bank_mask:0xf
    v_add_f32_dpp v62, v62, v62 row_ror:8 row_mask:0xf bank_mask:0xf
    v_add_f32_dpp v63, v63, v63 row_ror:8 row_mask:0xf bank_mask:0xf
    v_add_f32_dpp v60, v60, v60 row_ror:4 row_mask:0xf bank_mask:0xf
    v_add_f32_dpp v61, v61, v61 row_ror:4 row_mask:0xf bank_mask:0xf
    v_add_f32_dpp v62, v62, v62 row_ror:4 row_mask:0xf bank_mask:0xf
    v_add_f32_dpp v63, v63, v63 row_ror:4 row_mask:0xf bank_mask:0xf
    v_add_f32_dpp v60, v60, v60 row_ror:2 row_mask:0xf bank_mask:0xf
    v_add_f32_dpp v61, v61, v61 row_ror:2 row_mask:0xf bank_mask:0xf
    v_add_f32_dpp v62, v62, v62 row_ror:2 row_mask:0xf bank_mask:0xf
    v_add_f32_dpp v63, v63, v63 row_ror:2 row_mask:0xf bank_mask:0xf
    v_add_f32_dpp v60, v60, v60 row_ror:1 row_mask:0xf bank_mask:0xf
    v_add_f32_dpp v61, v61, v61 row_ror:1 row_mask:0xf bank_mask:0xf
    v_add_f32_dpp v62, v62, v62 row_ror:1 row_mask:0xf bank_mask:0xf
    v_add_f32_dpp v63, v63, v63 row_ror:1 row_mask:0xf bank_mask:0xf
    v_cvt_pk_bf16_f32 v84, v60, v61
    v_cvt_pk_bf16_f32 v85, v62, v63
    v_lshlrev_b32 v60, 16, v84
    v_and_b32 v61, s69, v84
    v_lshlrev_b32 v62, 16, v85
    v_and_b32 v63, s69, v85
    v_mul_f32 v60, s67, v60
    v_mul_f32 v61, s67, v61
    v_mul_f32 v62, s67, v62
    v_mul_f32 v63, s67, v63
    v_cvt_pk_bf16_f32 v84, v60, v61
    v_cvt_pk_bf16_f32 v85, v62, v63
    v_lshlrev_b32 v60, 16, v84
    v_and_b32 v61, s69, v84
    v_lshlrev_b32 v62, 16, v85
    v_and_b32 v63, s69, v85
    v_max3_f32 v86, v60, v61, v62
    v_max3_f32 v86, v86, v63, v52
    v_sub_f32 v66, v52, v86
    v_sub_f32 v60, v60, v86
    v_sub_f32 v61, v61, v86
    v_sub_f32 v62, v62, v86
    v_sub_f32 v63, v63, v86
    v_mul_f32 v66, s68, v66
    v_mul_f32 v60, s68, v60
    v_mul_f32 v61, s68, v61
    v_mul_f32 v62, s68, v62
    v_mul_f32 v63, s68, v63
    v_exp_f32 v66, v66
    v_exp_f32 v60, v60
    v_exp_f32 v61, v61
    v_exp_f32 v62, v62
    v_exp_f32 v63, v63
    v_mov_b32 v52, v86
    v_add_f32 v88, v60, v61
    v_add_f32 v89, v62, v63
    v_cvt_pk_bf16_f32 v76, v60, v61
    v_cvt_pk_bf16_f32 v77, v62, v63
    v_add_f32 v88, v88, v89
    v_fma_f32 v56, v56, v66, v88
    v_mul_f32 v20, v20, v66
    v_mul_f32 v21, v21, v66
    v_mul_f32 v22, v22, v66
    v_mul_f32 v23, v23, v66
    v_mul_f32 v24, v24, v66
    v_mul_f32 v25, v25, v66
    v_mul_f32 v26, v26, v66
    v_mul_f32 v27, v27, v66
    v_perm_b32 v84, v112, v108, s65
    v_perm_b32 v85, v112, v108, s66
    v_dot2_f32_bf16 v20, v84, v76, v20
    v_dot2_f32_bf16 v21, v85, v76, v21
    v_perm_b32 v86, v113, v109, s65
    v_perm_b32 v87, v113, v109, s66
    v_dot2_f32_bf16 v22, v86, v76, v22
    v_dot2_f32_bf16 v23, v87, v76, v23
    v_perm_b32 v84, v114, v110, s65
    v_perm_b32 v85, v114, v110, s66
    v_dot2_f32_bf16 v24, v84, v76, v24
    v_dot2_f32_bf16 v25, v85, v76, v25
    v_perm_b32 v86, v115, v111, s65
    v_perm_b32 v87, v115, v111, s66
    v_dot2_f32_bf16 v26, v86, v76, v26
    v_dot2_f32_bf16 v27, v87, v76, v27
    v_perm_b32 v84, v120, v116, s65
    v_perm_b32 v85, v120, v116, s66
    v_dot2_f32_bf16 v20, v84, v77, v20
    v_dot2_f32_bf16 v21, v85, v77, v21
    v_perm_b32 v86, v121, v117, s65
    v_perm_b32 v87, v121, v117, s66
    v_dot2_f32_bf16 v22, v86, v77, v22
    v_dot2_f32_bf16 v23, v87, v77, v23
    v_perm_b32 v84, v122, v118, s65
    v_perm_b32 v85, v122, v118, s66
    v_dot2_f32_bf16 v24, v84, v77, v24
    v_dot2_f32_bf16 v25, v85, v77, v25
    v_perm_b32 v86, v123, v119, s65
    v_perm_b32 v87, v123, v119, s66
    v_dot2_f32_bf16 v26, v86, v77, v26
    v_dot2_f32_bf16 v27, v87, v77, v27
    s_nop 2
    s_setpc_b64 s[84:85]
.LpairB_124:
    v_dot2_f32_bf16 v60, v124, v4, 0
    v_dot2_f32_bf16 v61, v128, v4, 0
    v_dot2_f32_bf16 v62, v132, v4, 0
    v_dot2_f32_bf16 v63, v136, v4, 0
    v_dot2_f32_bf16 v60, v125, v5, v60
    v_dot2_f32_bf16 v61, v129, v5, v61
    v_dot2_f32_bf16 v62, v133, v5, v62
    v_dot2_f32_bf16 v63, v137, v5, v63
    v_dot2_f32_bf16 v60, v126, v6, v60
    v_dot2_f32_bf16 v61, v130, v6, v61
    v_dot2_f32_bf16 v62, v134, v6, v62
    v_dot2_f32_bf16 v63, v138, v6, v63
    v_dot2_f32_bf16 v60, v127, v7, v60
    v_dot2_f32_bf16 v61, v131, v7, v61
    v_dot2_f32_bf16 v62, v135, v7, v62
    v_dot2_f32_bf16 v63, v139, v7, v63
    v_add_f32_dpp v60, v60, v60 row_ror:8 row_mask:0xf bank_mask:0xf
    v_add_f32_dpp v61, v61, v61 row_ror:8 row_mask:0xf bank_mask:0xf
    v_add_f32_dpp v62, v62, v62 row_ror:8 row_mask:0xf bank_mask:0xf
    v_add_f32_dpp v63, v63, v63 row_ror:8 row_mask:0xf bank_mask:0xf
    v_add_f32_dpp v60, v60, v60 row_ror:4 row_mask:0xf bank_mask:0xf
    v_add_f32_dpp v61, v61, v61 row_ror:4 row_mask:0xf bank_mask:0xf
    v_add_f32_dpp v62, v62, v62 row_ror:4 row_mask:0xf bank_mask:0xf
    v_add_f32_dpp v63, v63, v63 row_ror:4 row_mask:0xf bank_mask:0xf
    v_add_f32_dpp v60, v60, v60 row_ror:2 row_mask:0xf bank_mask:0xf
    v_add_f32_dpp v61, v61, v61 row_ror:2 row_mask:0xf bank_mask:0xf
    v_add_f32_dpp v62, v62, v62 row_ror:2 row_mask:0xf bank_mask:0xf
    v_add_f32_dpp v63, v63, v63 row_ror:2 row_mask:0xf bank_mask:0xf
    v_add_f32_dpp v60, v60, v60 row_ror:1 row_mask:0xf bank_mask:0xf
    v_add_f32_dpp v61, v61, v61 row_ror:1 row_mask:0xf bank_mask:0xf
    v_add_f32_dpp v62, v62, v62 row_ror:1 row_mask:0xf bank_mask:0xf
    v_add_f32_dpp v63, v63, v63 row_ror:1 row_mask:0xf bank_mask:0xf
    v_cvt_pk_bf16_f32 v84, v60, v61
    v_cvt_pk_bf16_f32 v85, v62, v63
    v_lshlrev_b32 v60, 16, v84
    v_and_b32 v61, s69, v84
    v_lshlrev_b32 v62, 16, v85
    v_and_b32 v63, s69, v85
    v_mul_f32 v60, s67, v60
    v_mul_f32 v61, s67, v61
    v_mul_f32 v62, s67, v62
    v_mul_f32 v63, s67, v63
    v_cvt_pk_bf16_f32 v84, v60, v61
    v_cvt_pk_bf16_f32 v85, v62, v63
    v_lshlrev_b32 v60, 16, v84
    v_and_b32 v61, s69, v84
    v_lshlrev_b32 v62, 16, v85
    v_and_b32 v63, s69, v85
    v_max3_f32 v86, v60, v61, v62
    v_max3_f32 v86, v86, v63, v52
    v_sub_f32 v66, v52, v86
    v_sub_f32 v60, v60, v86
    v_sub_f32 v61, v61, v86
    v_sub_f32 v62, v62, v86
    v_sub_f32 v63, v63, v86
    v_mul_f32 v66, s68, v66
    v_mul_f32 v60, s68, v60
    v_mul_f32 v61, s68, v61
    v_mul_f32 v62, s68, v62
    v_mul_f32 v63, s68, v63
    v_exp_f32 v66, v66
    v_exp_f32 v60, v60
    v_exp_f32 v61, v61
    v_exp_f32 v62, v62
    v_exp_f32 v63, v63
    v_mov_b32 v52, v86
    v_add_f32 v88, v60, v61
    v_add_f32 v89, v62, v63
    v_cvt_pk_bf16_f32 v76, v60, v61
    v_cvt_pk_bf16_f32 v77, v62, v63
    v_add_f32 v88, v88, v89
    v_fma_f32 v56, v56, v66, v88
    v_mul_f32 v20, v20, v66
    v_mul_f32 v21, v21, v66
    v_mul_f32 v22, v22, v66
    v_mul_f32 v23, v23, v66
    v_mul_f32 v24, v24, v66
    v_mul_f32 v25, v25, v66
    v_mul_f32 v26, v26, v66
    v_mul_f32 v27, v27, v66
    v_perm_b32 v84, v144, v140, s65
    v_perm_b32 v85, v144, v140, s66
    v_dot2_f32_bf16 v20, v84, v76, v20
    v_dot2_f32_bf16 v21, v85, v76, v21
    v_perm_b32 v86, v145, v141, s65
    v_perm_b32 v87, v145, v141, s66
    v_dot2_f32_bf16 v22, v86, v76, v22
    v_dot2_f32_bf16 v23, v87, v76, v23
    v_perm_b32 v84, v146, v142, s65
    v_perm_b32 v85, v146, v142, s66
    v_dot2_f32_bf16 v24, v84, v76, v24
    v_dot2_f32_bf16 v25, v85, v76, v25
    v_perm_b32 v86, v147, v143, s65
    v_perm_b32 v87, v147, v143, s66
    v_dot2_f32_bf16 v26, v86, v76, v26
    v_dot2_f32_bf16 v27, v87, v76, v27
    v_perm_b32 v84, v152, v148, s65
    v_perm_b32 v85, v152, v148, s66
    v_dot2_f32_bf16 v20, v84, v77, v20
    v_dot2_f32_bf16 v21, v85, v77, v21
    v_perm_b32 v86, v153, v149, s65
    v_perm_b32 v87, v153, v149, s66
    v_dot2_f32_bf16 v22, v86, v77, v22
    v_dot2_f32_bf16 v23, v87, v77, v23
    v_perm_b32 v84, v154, v150, s65
    v_perm_b32 v85, v154, v150, s66
    v_dot2_f32_bf16 v24, v84, v77, v24
    v_dot2_f32_bf16 v25, v85, v77, v25
    v_perm_b32 v86, v155, v151, s65
    v_perm_b32 v87, v155, v151, s66
    v_dot2_f32_bf16 v26, v86, v77, v26
    v_dot2_f32_bf16 v27, v87, v77, v27
    s_nop 2
    s_setpc_b64 s[84:85]
.LpairB_156:
    v_dot2_f32_bf16 v60, v156, v4, 0
    v_dot2_f32_bf16 v61, v160, v4, 0
    v_dot2_f32_bf16 v62, v164, v4, 0
    v_dot2_f32_bf16 v63, v168, v4, 0
    v_dot2_f32_bf16 v60, v157, v5, v60
    v_dot2_f32_bf16 v61, v161, v5, v61
    v_dot2_f32_bf16 v62, v165, v5, v62
    v_dot2_f32_bf16 v63, v169, v5, v63
    v_dot2_f32_bf16 v60, v158, v6, v60
    v_dot2_f32_bf16 v61, v162, v6, v61
    v_dot2_f32_bf16 v62, v166, v6, v62
    v_dot2_f32_bf16 v63, v170, v6, v63
    v_dot2_f32_bf16 v60, v159, v7, v60
    v_dot2_f32_bf16 v61, v163, v7, v61
    v_dot2_f32_bf16 v62, v167, v7, v62
    v_dot2_f32_bf16 v63, v171, v7, v63
    v_add_f32_dpp v60, v60, v60 row_ror:8 row_mask:0xf bank_mask:0xf
    v_add_f32_dpp v61, v61, v61 row_ror:8 row_mask:0xf bank_mask:0xf
    v_add_f32_dpp v62, v62, v62 row_ror:8 row_mask:0xf bank_mask:0xf
    v_add_f32_dpp v63, v63, v63 row_ror:8 row_mask:0xf bank_mask:0xf
    v_add_f32_dpp v60, v60, v60 row_ror:4 row_mask:0xf bank_mask:0xf
    v_add_f32_dpp v61, v61, v61 row_ror:4 row_mask:0xf bank_mask:0xf
    v_add_f32_dpp v62, v62, v62 row_ror:4 row_mask:0xf bank_mask:0xf
    v_add_f32_dpp v63, v63, v63 row_ror:4 row_mask:0xf bank_mask:0xf
    v_add_f32_dpp v60, v60, v60 row_ror:2 row_mask:0xf bank_mask:0xf
    v_add_f32_dpp v61, v61, v61 row_ror:2 row_mask:0xf bank_mask:0xf
    v_add_f32_dpp v62, v62, v62 row_ror:2 row_mask:0xf bank_mask:0xf
    v_add_f32_dpp v63, v63, v63 row_ror:2 row_mask:0xf bank_mask:0xf
    v_add_f32_dpp v60, v60, v60 row_ror:1 row_mask:0xf bank_mask:0xf
    v_add_f32_dpp v61, v61, v61 row_ror:1 row_mask:0xf bank_mask:0xf
    v_add_f32_dpp v62, v62, v62 row_ror:1 row_mask:0xf bank_mask:0xf
    v_add_f32_dpp v63, v63, v63 row_ror:1 row_mask:0xf bank_mask:0xf
    v_cvt_pk_bf16_f32 v84, v60, v61
    v_cvt_pk_bf16_f32 v85, v62, v63
    v_lshlrev_b32 v60, 16, v84
    v_and_b32 v61, s69, v84
    v_lshlrev_b32 v62, 16, v85
    v_and_b32 v63, s69, v85
    v_mul_f32 v60, s67, v60
    v_mul_f32 v61, s67, v61
    v_mul_f32 v62, s67, v62
    v_mul_f32 v63, s67, v63
    v_cvt_pk_bf16_f32 v84, v60, v61
    v_cvt_pk_bf16_f32 v85, v62, v63
    v_lshlrev_b32 v60, 16, v84
    v_and_b32 v61, s69, v84
    v_lshlrev_b32 v62, 16, v85
    v_and_b32 v63, s69, v85
    v_max3_f32 v86, v60, v61, v62
    v_max3_f32 v86, v86, v63, v52
    v_sub_f32 v66, v52, v86
    v_sub_f32 v60, v60, v86
    v_sub_f32 v61, v61, v86
    v_sub_f32 v62, v62, v86
    v_sub_f32 v63, v63, v86
    v_mul_f32 v66, s68, v66
    v_mul_f32 v60, s68, v60
    v_mul_f32 v61, s68, v61
    v_mul_f32 v62, s68, v62
    v_mul_f32 v63, s68, v63
    v_exp_f32 v66, v66
    v_exp_f32 v60, v60
    v_exp_f32 v61, v61
    v_exp_f32 v62, v62
    v_exp_f32 v63, v63
    v_mov_b32 v52, v86
    v_add_f32 v88, v60, v61
    v_add_f32 v89, v62, v63
    v_cvt_pk_bf16_f32 v76, v60, v61
    v_cvt_pk_bf16_f32 v77, v62, v63
    v_add_f32 v88, v88, v89
    v_fma_f32 v56, v56, v66, v88
    v_mul_f32 v20, v20, v66
    v_mul_f32 v21, v21, v66
    v_mul_f32 v22, v22, v66
    v_mul_f32 v23, v23, v66
    v_mul_f32 v24, v24, v66
    v_mul_f32 v25, v25, v66
    v_mul_f32 v26, v26, v66
    v_mul_f32 v27, v27, v66
    v_perm_b32 v84, v176, v172, s65
    v_perm_b32 v85, v176, v172, s66
    v_dot2_f32_bf16 v20, v84, v76, v20
    v_dot2_f32_bf16 v21, v85, v76, v21
    v_perm_b32 v86, v177, v173, s65
    v_perm_b32 v87, v177, v173, s66
    v_dot2_f32_bf16 v22, v86, v76, v22
    v_dot2_f32_bf16 v23, v87, v76, v23
    v_perm_b32 v84, v178, v174, s65
    v_perm_b32 v85, v178, v174, s66
    v_dot2_f32_bf16 v24, v84, v76, v24
    v_dot2_f32_bf16 v25, v85, v76, v25
    v_perm_b32 v86, v179, v175, s65
    v_perm_b32 v87, v179, v175, s66
    v_dot2_f32_bf16 v26, v86, v76, v26
    v_dot2_f32_bf16 v27, v87, v76, v27
    v_perm_b32 v84, v184, v180, s65
    v_perm_b32 v85, v184, v180, s66
    v_dot2_f32_bf16 v20, v84, v77, v20
    v_dot2_f32_bf16 v21, v85, v77, v21
    v_perm_b32 v86, v185, v181, s65
    v_perm_b32 v87, v185, v181, s66
    v_dot2_f32_bf16 v22, v86, v77, v22
    v_dot2_f32_bf16 v23, v87, v77, v23
    v_perm_b32 v84, v186, v182, s65
    v_perm_b32 v85, v186, v182, s66
    v_dot2_f32_bf16 v24, v84, v77, v24
    v_dot2_f32_bf16 v25, v85, v77, v25
    v_perm_b32 v86, v187, v183, s65
    v_perm_b32 v87, v187, v183, s66
    v_dot2_f32_bf16 v26, v86, v77, v26
    v_dot2_f32_bf16 v27, v87, v77, v27
    s_nop 2
    s_setpc_b64 s[84:85]
.LpairB_188:
    v_dot2_f32_bf16 v60, v188, v4, 0
    v_dot2_f32_bf16 v61, v192, v4, 0
    v_dot2_f32_bf16 v62, v196, v4, 0
    v_dot2_f32_bf16 v63, v200, v4, 0
    v_dot2_f32_bf16 v60, v189, v5, v60
    v_dot2_f32_bf16 v61, v193, v5, v61
    v_dot2_f32_bf16 v62, v197, v5, v62
    v_dot2_f32_bf16 v63, v201, v5, v63
    v_dot2_f32_bf16 v60, v190, v6, v60
    v_dot2_f32_bf16 v61, v194, v6, v61
    v_dot2_f32_bf16 v62, v198, v6, v62
    v_dot2_f32_bf16 v63, v202, v6, v63
    v_dot2_f32_bf16 v60, v191, v7, v60
    v_dot2_f32_bf16 v61, v195, v7, v61
    v_dot2_f32_bf16 v62, v199, v7, v62
    v_dot2_f32_bf16 v63, v203, v7, v63
    v_add_f32_dpp v60, v60, v60 row_ror:8 row_mask:0xf bank_mask:0xf
    v_add_f32_dpp v61, v61, v61 row_ror:8 row_mask:0xf bank_mask:0xf
    v_add_f32_dpp v62, v62, v62 row_ror:8 row_mask:0xf bank_mask:0xf
    v_add_f32_dpp v63, v63, v63 row_ror:8 row_mask:0xf bank_mask:0xf
    v_add_f32_dpp v60, v60, v60 row_ror:4 row_mask:0xf bank_mask:0xf
    v_add_f32_dpp v61, v61, v61 row_ror:4 row_mask:0xf bank_mask:0xf
    v_add_f32_dpp v62, v62, v62 row_ror:4 row_mask:0xf bank_mask:0xf
    v_add_f32_dpp v63, v63, v63 row_ror:4 row_mask:0xf bank_mask:0xf
    v_add_f32_dpp v60, v60, v60 row_ror:2 row_mask:0xf bank_mask:0xf
    v_add_f32_dpp v61, v61, v61 row_ror:2 row_mask:0xf bank_mask:0xf
    v_add_f32_dpp v62, v62, v62 row_ror:2 row_mask:0xf bank_mask:0xf
    v_add_f32_dpp v63, v63, v63 row_ror:2 row_mask:0xf bank_mask:0xf
    v_add_f32_dpp v60, v60, v60 row_ror:1 row_mask:0xf bank_mask:0xf
    v_add_f32_dpp v61, v61, v61 row_ror:1 row_mask:0xf bank_mask:0xf
    v_add_f32_dpp v62, v62, v62 row_ror:1 row_mask:0xf bank_mask:0xf
    v_add_f32_dpp v63, v63, v63 row_ror:1 row_mask:0xf bank_mask:0xf
    v_cvt_pk_bf16_f32 v84, v60, v61
    v_cvt_pk_bf16_f32 v85, v62, v63
    v_lshlrev_b32 v60, 16, v84
    v_and_b32 v61, s69, v84
    v_lshlrev_b32 v62, 16, v85
    v_and_b32 v63, s69, v85
    v_mul_f32 v60, s67, v60
    v_mul_f32 v61, s67, v61
    v_mul_f32 v62, s67, v62
    v_mul_f32 v63, s67, v63
    v_cvt_pk_bf16_f32 v84, v60, v61
    v_cvt_pk_bf16_f32 v85, v62, v63
    v_lshlrev_b32 v60, 16, v84
    v_and_b32 v61, s69, v84
    v_lshlrev_b32 v62, 16, v85
    v_and_b32 v63, s69, v85
    v_max3_f32 v86, v60, v61, v62
    v_max3_f32 v86, v86, v63, v52
    v_sub_f32 v66, v52, v86
    v_sub_f32 v60, v60, v86
    v_sub_f32 v61, v61, v86
    v_sub_f32 v62, v62, v86
    v_sub_f32 v63, v63, v86
    v_mul_f32 v66, s68, v66
    v_mul_f32 v60, s68, v60
    v_mul_f32 v61, s68, v61
    v_mul_f32 v62, s68, v62
    v_mul_f32 v63, s68, v63
    v_exp_f32 v66, v66
    v_exp_f32 v60, v60
    v_exp_f32 v61, v61
    v_exp_f32 v62, v62
    v_exp_f32 v63, v63
    v_mov_b32 v52, v86
    v_add_f32 v88, v60, v61
    v_add_f32 v89, v62, v63
    v_cvt_pk_bf16_f32 v76, v60, v61
    v_cvt_pk_bf16_f32 v77, v62, v63
    v_add_f32 v88, v88, v89
    v_fma_f32 v56, v56, v66, v88
    v_mul_f32 v20, v20, v66
    v_mul_f32 v21, v21, v66
    v_mul_f32 v22, v22, v66
    v_mul_f32 v23, v23, v66
    v_mul_f32 v24, v24, v66
    v_mul_f32 v25, v25, v66
    v_mul_f32 v26, v26, v66
    v_mul_f32 v27, v27, v66
    v_perm_b32 v84, v208, v204, s65
    v_perm_b32 v85, v208, v204, s66
    v_dot2_f32_bf16 v20, v84, v76, v20
    v_dot2_f32_bf16 v21, v85, v76, v21
    v_perm_b32 v86, v209, v205, s65
    v_perm_b32 v87, v209, v205, s66
    v_dot2_f32_bf16 v22, v86, v76, v22
    v_dot2_f32_bf16 v23, v87, v76, v23
    v_perm_b32 v84, v210, v206, s65
    v_perm_b32 v85, v210, v206, s66
    v_dot2_f32_bf16 v24, v84, v76, v24
    v_dot2_f32_bf16 v25, v85, v76, v25
    v_perm_b32 v86, v211, v207, s65
    v_perm_b32 v87, v211, v207, s66
    v_dot2_f32_bf16 v26, v86, v76, v26
    v_dot2_f32_bf16 v27, v87, v76, v27
    v_perm_b32 v84, v216, v212, s65
    v_perm_b32 v85, v216, v212, s66
    v_dot2_f32_bf16 v20, v84, v77, v20
    v_dot2_f32_bf16 v21, v85, v77, v21
    v_perm_b32 v86, v217, v213, s65
    v_perm_b32 v87, v217, v213, s66
    v_dot2_f32_bf16 v22, v86, v77, v22
    v_dot2_f32_bf16 v23, v87, v77, v23
    v_perm_b32 v84, v218, v214, s65
    v_perm_b32 v85, v218, v214, s66
    v_dot2_f32_bf16 v24, v84, v77, v24
    v_dot2_f32_bf16 v25, v85, v77, v25
    v_perm_b32 v86, v219, v215, s65
    v_perm_b32 v87, v219, v215, s66
    v_dot2_f32_bf16 v26, v86, v77, v26
    v_dot2_f32_bf16 v27, v87, v77, v27
    s_nop 2
    s_setpc_b64 s[84:85]
.LpairB_220:
    v_dot2_f32_bf16 v60, v220, v4, 0
    v_dot2_f32_bf16 v61, v224, v4, 0
    v_dot2_f32_bf16 v62, v228, v4, 0
    v_dot2_f32_bf16 v63, v232, v4, 0
    v_dot2_f32_bf16 v60, v221, v5, v60
    v_dot2_f32_bf16 v61, v225, v5, v61
    v_dot2_f32_bf16 v62, v229, v5, v62
    v_dot2_f32_bf16 v63, v233, v5, v63
    v_dot2_f32_bf16 v60, v222, v6, v60
    v_dot2_f32_bf16 v61, v226, v6, v61
    v_dot2_f32_bf16 v62, v230, v6, v62
    v_dot2_f32_bf16 v63, v234, v6, v63
    v_dot2_f32_bf16 v60, v223, v7, v60
    v_dot2_f32_bf16 v61, v227, v7, v61
    v_dot2_f32_bf16 v62, v231, v7, v62
    v_dot2_f32_bf16 v63, v235, v7, v63
    v_add_f32_dpp v60, v60, v60 row_ror:8 row_mask:0xf bank_mask:0xf
    v_add_f32_dpp v61, v61, v61 row_ror:8 row_mask:0xf bank_mask:0xf
    v_add_f32_dpp v62, v62, v62 row_ror:8 row_mask:0xf bank_mask:0xf
    v_add_f32_dpp v63, v63, v63 row_ror:8 row_mask:0xf bank_mask:0xf
    v_add_f32_dpp v60, v60, v60 row_ror:4 row_mask:0xf bank_mask:0xf
    v_add_f32_dpp v61, v61, v61 row_ror:4 row_mask:0xf bank_mask:0xf
    v_add_f32_dpp v62, v62, v62 row_ror:4 row_mask:0xf bank_mask:0xf
    v_add_f32_dpp v63, v63, v63 row_ror:4 row_mask:0xf bank_mask:0xf
    v_add_f32_dpp v60, v60, v60 row_ror:2 row_mask:0xf bank_mask:0xf
    v_add_f32_dpp v61, v61, v61 row_ror:2 row_mask:0xf bank_mask:0xf
    v_add_f32_dpp v62, v62, v62 row_ror:2 row_mask:0xf bank_mask:0xf
    v_add_f32_dpp v63, v63, v63 row_ror:2 row_mask:0xf bank_mask:0xf
    v_add_f32_dpp v60, v60, v60 row_ror:1 row_mask:0xf bank_mask:0xf
    v_add_f32_dpp v61, v61, v61 row_ror:1 row_mask:0xf bank_mask:0xf
    v_add_f32_dpp v62, v62, v62 row_ror:1 row_mask:0xf bank_mask:0xf
    v_add_f32_dpp v63, v63, v63 row_ror:1 row_mask:0xf bank_mask:0xf
    v_cvt_pk_bf16_f32 v84, v60, v61
    v_cvt_pk_bf16_f32 v85, v62, v63
    v_lshlrev_b32 v60, 16, v84
    v_and_b32 v61, s69, v84
    v_lshlrev_b32 v62, 16, v85
    v_and_b32 v63, s69, v85
    v_mul_f32 v60, s67, v60
    v_mul_f32 v61, s67, v61
    v_mul_f32 v62, s67, v62
    v_mul_f32 v63, s67, v63
    v_cvt_pk_bf16_f32 v84, v60, v61
    v_cvt_pk_bf16_f32 v85, v62, v63
    v_lshlrev_b32 v60, 16, v84
    v_and_b32 v61, s69, v84
    v_lshlrev_b32 v62, 16, v85
    v_and_b32 v63, s69, v85
    v_max3_f32 v86, v60, v61, v62
    v_max3_f32 v86, v86, v63, v52
    v_sub_f32 v66, v52, v86
    v_sub_f32 v60, v60, v86
    v_sub_f32 v61, v61, v86
    v_sub_f32 v62, v62, v86
    v_sub_f32 v63, v63, v86
    v_mul_f32 v66, s68, v66
    v_mul_f32 v60, s68, v60
    v_mul_f32 v61, s68, v61
    v_mul_f32 v62, s68, v62
    v_mul_f32 v63, s68, v63
    v_exp_f32 v66, v66
    v_exp_f32 v60, v60
    v_exp_f32 v61, v61
    v_exp_f32 v62, v62
    v_exp_f32 v63, v63
    v_mov_b32 v52, v86
    v_add_f32 v88, v60, v61
    v_add_f32 v89, v62, v63
    v_cvt_pk_bf16_f32 v76, v60, v61
    v_cvt_pk_bf16_f32 v77, v62, v63
    v_add_f32 v88, v88, v89
    v_fma_f32 v56, v56, v66, v88
    v_mul_f32 v20, v20, v66
    v_mul_f32 v21, v21, v66
    v_mul_f32 v22, v22, v66
    v_mul_f32 v23, v23, v66
    v_mul_f32 v24, v24, v66
    v_mul_f32 v25, v25, v66
    v_mul_f32 v26, v26, v66
    v_mul_f32 v27, v27, v66
    v_perm_b32 v84, v240, v236, s65
    v_perm_b32 v85, v240, v236, s66
    v_dot2_f32_bf16 v20, v84, v76, v20
    v_dot2_f32_bf16 v21, v85, v76, v21
    v_perm_b32 v86, v241, v237, s65
    v_perm_b32 v87, v241, v237, s66
    v_dot2_f32_bf16 v22, v86, v76, v22
    v_dot2_f32_bf16 v23, v87, v76, v23
    v_perm_b32 v84, v242, v238, s65
    v_perm_b32 v85, v242, v238, s66
    v_dot2_f32_bf16 v24, v84, v76, v24
    v_dot2_f32_bf16 v25, v85, v76, v25
    v_perm_b32 v86, v243, v239, s65
    v_perm_b32 v87, v243, v239, s66
    v_dot2_f32_bf16 v26, v86, v76, v26
    v_dot2_f32_bf16 v27, v87, v76, v27
    v_perm_b32 v84, v248, v244, s65
    v_perm_b32 v85, v248, v244, s66
    v_dot2_f32_bf16 v20, v84, v77, v20
    v_dot2_f32_bf16 v21, v85, v77, v21
    v_perm_b32 v86, v249, v245, s65
    v_perm_b32 v87, v249, v245, s66
    v_dot2_f32_bf16 v22, v86, v77, v22
    v_dot2_f32_bf16 v23, v87, v77, v23
    v_perm_b32 v84, v250, v246, s65
    v_perm_b32 v85, v250, v246, s66
    v_dot2_f32_bf16 v24, v84, v77, v24
    v_dot2_f32_bf16 v25, v85, v77, v25
    v_perm_b32 v86, v251, v247, s65
    v_perm_b32 v87, v251, v247, s66
    v_dot2_f32_bf16 v26, v86, v77, v26
    v_dot2_f32_bf16 v27, v87, v77, v27
    s_nop 2
    s_setpc_b64 s[84:85]
.LstK_156:
    ds_write_b128 v53, v[156:159] offset:0
    v_xor_b32 v85, 64, v53
    ds_write_b128 v85, v[160:163] offset:1024
    v_xor_b32 v86, 128, v53
    ds_write_b128 v86, v[164:167] offset:2048
    v_xor_b32 v87, 192, v53
    ds_write_b128 v87, v[168:171] offset:3072
    ds_read_b128 v[156:159], v54
    v_xor_b32 v89, 64, v54
    ds_read_b128 v[160:163], v89
    v_xor_b32 v90, 128, v54
    ds_read_b128 v[164:167], v90
    v_xor_b32 v91, 192, v54
    ds_read_b128 v[168:171], v91
    s_nop 1
.LqkA_156:
    s_waitcnt lgkmcnt(0)
    v_mfma_f32_16x16x32_bf16 v[60:63], v[156:159], v[4:7], 0
    v_mfma_f32_16x16x32_bf16 v[60:63], v[160:163], v[8:11], v[60:63]
    v_mfma_f32_16x16x32_bf16 v[60:63], v[164:167], v[12:15], v[60:63]
    v_mfma_f32_16x16x32_bf16 v[60:63], v[168:171], v[16:19], v[60:63]
    s_nop 8
    v_cvt_pk_bf16_f32 v84, v60, v61
    v_cvt_pk_bf16_f32 v85, v62, v63
    v_lshlrev_b32 v60, 16, v84
    v_and_b32 v61, s69, v84
    v_lshlrev_b32 v62, 16, v85
    v_and_b32 v63, s69, v85
    v_mul_f32 v60, s67, v60
    v_mul_f32 v61, s67, v61
    v_mul_f32 v62, s67, v62
    v_mul_f32 v63, s67, v63
    v_cvt_pk_bf16_f32 v84, v60, v61
    v_cvt_pk_bf16_f32 v85, v62, v63
    v_lshlrev_b32 v60, 16, v84
    v_and_b32 v61, s69, v84
    v_lshlrev_b32 v62, 16, v85
    v_and_b32 v63, s69, v85
    v_max3_f32 v86, v60, v61, v62
    v_max3_f32 v86, v86, v63, v52
    v_mov_b32 v87, v86
    s_nop 1
    v_permlane32_swap_b32 v86, v87
    v_max_f32 v86, v86, v87
    v_mov_b32 v87, v86
    s_nop 1
    v_permlane16_swap_b32 v86, v87
    v_max_f32 v86, v86, v87
    v_sub_f32 v82, v52, v86
    v_sub_f32 v60, v60, v86
    v_sub_f32 v61, v61, v86
    v_sub_f32 v62, v62, v86
    v_sub_f32 v63, v63, v86
    v_mul_f32 v82, s68, v82
    v_mul_f32 v60, s68, v60
    v_mul_f32 v61, s68, v61
    v_mul_f32 v62, s68, v62
    v_mul_f32 v63, s68, v63
    v_exp_f32 v82, v82
    v_exp_f32 v60, v60
    v_exp_f32 v61, v61
    v_exp_f32 v62, v62
    v_exp_f32 v63, v63
    v_mov_b32 v52, v86
    v_readlane_b32 s72, v82, 0
    v_readlane_b32 s73, v82, 1
    v_readlane_b32 s74, v82, 2
    v_readlane_b32 s75, v82, 3
    v_add_f32 v88, v60, v61
    v_add_f32 v89, v62, v63
    v_cvt_pk_bf16_f32 v80, v60, v61
    v_cvt_pk_bf16_f32 v81, v62, v63
    v_add_f32 v88, v88, v89
    v_fma_f32 v56, v56, v82, v88
    v_pk_mul_f32 v[20:21], v[20:21], s[72:73]
    v_pk_mul_f32 v[22:23], v[22:23], s[74:75]
    v_pk_mul_f32 v[24:25], v[24:25], s[72:73]
    v_pk_mul_f32 v[26:27], v[26:27], s[74:75]
    v_pk_mul_f32 v[28:29], v[28:29], s[72:73]
    v_pk_mul_f32 v[30:31], v[30:31], s[74:75]
    v_pk_mul_f32 v[32:33], v[32:33], s[72:73]
    v_pk_mul_f32 v[34:35], v[34:35], s[74:75]
    v_pk_mul_f32 v[36:37], v[36:37], s[72:73]
    v_pk_mul_f32 v[38:39], v[38:39], s[74:75]
    v_pk_mul_f32 v[40:41], v[40:41], s[72:73]
    v_pk_mul_f32 v[42:43], v[42:43], s[74:75]
    v_pk_mul_f32 v[44:45], v[44:45], s[72:73]
    v_pk_mul_f32 v[46:47], v[46:47], s[74:75]
    v_pk_mul_f32 v[48:49], v[48:49], s[72:73]
    v_pk_mul_f32 v[50:51], v[50:51], s[74:75]
    s_nop 2
    s_setpc_b64 s[84:85]
.LstK_172:
    ds_write_b128 v53, v[172:175] offset:0
    v_xor_b32 v85, 64, v53
    ds_write_b128 v85, v[176:179] offset:1024
    v_xor_b32 v86, 128, v53
    ds_write_b128 v86, v[180:183] offset:2048
    v_xor_b32 v87, 192, v53
    ds_write_b128 v87, v[184:187] offset:3072
    ds_read_b128 v[172:175], v54
    v_xor_b32 v89, 64, v54
    ds_read_b128 v[176:179], v89
    v_xor_b32 v90, 128, v54
    ds_read_b128 v[180:183], v90
    v_xor_b32 v91, 192, v54
    ds_read_b128 v[184:187], v91
    s_nop 1
.LqkA_172:
    s_waitcnt lgkmcnt(0)
    v_mfma_f32_16x16x32_bf16 v[60:63], v[172:175], v[4:7], 0
    v_mfma_f32_16x16x32_bf16 v[60:63], v[176:179], v[8:11], v[60:63]
    v_mfma_f32_16x16x32_bf16 v[60:63], v[180:183], v[12:15], v[60:63]
    v_mfma_f32_16x16x32_bf16 v[60:63], v[184:187], v[16:19], v[60:63]
    s_nop 8
    v_cvt_pk_bf16_f32 v84, v60, v61
    v_cvt_pk_bf16_f32 v85, v62, v63
    v_lshlrev_b32 v60, 16, v84
    v_and_b32 v61, s69, v84
    v_lshlrev_b32 v62, 16, v85
    v_and_b32 v63, s69, v85
    v_mul_f32 v60, s67, v60
    v_mul_f32 v61, s67, v61
    v_mul_f32 v62, s67, v62
    v_mul_f32 v63, s67, v63
    v_cvt_pk_bf16_f32 v84, v60, v61
    v_cvt_pk_bf16_f32 v85, v62, v63
    v_lshlrev_b32 v60, 16, v84
    v_and_b32 v61, s69, v84
    v_lshlrev_b32 v62, 16, v85
    v_and_b32 v63, s69, v85
    v_max3_f32 v86, v60, v61, v62
    v_max3_f32 v86, v86, v63, v52
    v_mov_b32 v87, v86
    s_nop 1
    v_permlane32_swap_b32 v86, v87
    v_max_f32 v86, v86, v87
    v_mov_b32 v87, v86
    s_nop 1
    v_permlane16_swap_b32 v86, v87
    v_max_f32 v86, v86, v87
    v_sub_f32 v82, v52, v86
    v_sub_f32 v60, v60, v86
    v_sub_f32 v61, v61, v86
    v_sub_f32 v62, v62, v86
    v_sub_f32 v63, v63, v86
    v_mul_f32 v82, s68, v82
    v_mul_f32 v60, s68, v60
    v_mul_f32 v61, s68, v61
    v_mul_f32 v62, s68, v62
    v_mul_f32 v63, s68, v63
    v_exp_f32 v82, v82
    v_exp_f32 v60, v60
    v_exp_f32 v61, v61
    v_exp_f32 v62, v62
    v_exp_f32 v63, v63
    v_mov_b32 v52, v86
    v_readlane_b32 s72, v82, 0
    v_readlane_b32 s73, v82, 1
    v_readlane_b32 s74, v82, 2
    v_readlane_b32 s75, v82, 3
    v_add_f32 v88, v60, v61
    v_add_f32 v89, v62, v63
    v_cvt_pk_bf16_f32 v80, v60, v61
    v_cvt_pk_bf16_f32 v81, v62, v63
    v_add_f32 v88, v88, v89
    v_fma_f32 v56, v56, v82, v88
    v_pk_mul_f32 v[20:21], v[20:21], s[72:73]
    v_pk_mul_f32 v[22:23], v[22:23], s[74:75]
    v_pk_mul_f32 v[24:25], v[24:25], s[72:73]
    v_pk_mul_f32 v[26:27], v[26:27], s[74:75]
    v_pk_mul_f32 v[28:29], v[28:29], s[72:73]
    v_pk_mul_f32 v[30:31], v[30:31], s[74:75]
    v_pk_mul_f32 v[32:33], v[32:33], s[72:73]
    v_pk_mul_f32 v[34:35], v[34:35], s[74:75]
    v_pk_mul_f32 v[36:37], v[36:37], s[72:73]
    v_pk_mul_f32 v[38:39], v[38:39], s[74:75]
    v_pk_mul_f32 v[40:41], v[40:41], s[72:73]
    v_pk_mul_f32 v[42:43], v[42:43], s[74:75]
    v_pk_mul_f32 v[44:45], v[44:45], s[72:73]
    v_pk_mul_f32 v[46:47], v[46:47], s[74:75]
    v_pk_mul_f32 v[48:49], v[48:49], s[72:73]
    v_pk_mul_f32 v[50:51], v[50:51], s[74:75]
    s_nop 2
    s_setpc_b64 s[84:85]
.LstK_188:
    ds_write_b128 v53, v[188:191] offset:0
    v_xor_b32 v85, 64, v53
    ds_write_b128 v85, v[192:195] offset:1024
    v_xor_b32 v86, 128, v53
    ds_write_b128 v86, v[196:199] offset:2048
    v_xor_b32 v87, 192, v53
    ds_write_b128 v87, v[200:203] offset:3072
    ds_read_b128 v[188:191], v54
    v_xor_b32 v89, 64, v54
    ds_read_b128 v[192:195], v89
    v_xor_b32 v90, 128, v54
    ds_read_b128 v[196:199], v90
    v_xor_b32 v91, 192, v54
    ds_read_b128 v[200:203], v91
    s_nop 1
.LqkA_188:
    s_waitcnt lgkmcnt(0)
    v_mfma_f32_16x16x32_bf16 v[60:63], v[188:191], v[4:7], 0
    v_mfma_f32_16x16x32_bf16 v[60:63], v[192:195], v[8:11], v[60:63]
    v_mfma_f32_16x16x32_bf16 v[60:63], v[196:199], v[12:15], v[60:63]
    v_mfma_f32_16x16x32_bf16 v[60:63], v[200:203], v[16:19], v[60:63]
    s_nop 8
    v_cvt_pk_bf16_f32 v84, v60, v61
    v_cvt_pk_bf16_f32 v85, v62, v63
    v_lshlrev_b32 v60, 16, v84
    v_and_b32 v61, s69, v84
    v_lshlrev_b32 v62, 16, v85
    v_and_b32 v63, s69, v85
    v_mul_f32 v60, s67, v60
    v_mul_f32 v61, s67, v61
    v_mul_f32 v62, s67, v62
    v_mul_f32 v63, s67, v63
    v_cvt_pk_bf16_f32 v84, v60, v61
    v_cvt_pk_bf16_f32 v85, v62, v63
    v_lshlrev_b32 v60, 16, v84
    v_and_b32 v61, s69, v84
    v_lshlrev_b32 v62, 16, v85
    v_and_b32 v63, s69, v85
    v_max3_f32 v86, v60, v61, v62
    v_max3_f32 v86, v86, v63, v52
    v_mov_b32 v87, v86
    s_nop 1
    v_permlane32_swap_b32 v86, v87
    v_max_f32 v86, v86, v87
    v_mov_b32 v87, v86
    s_nop 1
    v_permlane16_swap_b32 v86, v87
    v_max_f32 v86, v86, v87
    v_sub_f32 v82, v52, v86
    v_sub_f32 v60, v60, v86
    v_sub_f32 v61, v61, v86
    v_sub_f32 v62, v62, v86
    v_sub_f32 v63, v63, v86
    v_mul_f32 v82, s68, v82
    v_mul_f32 v60, s68, v60
    v_mul_f32 v61, s68, v61
    v_mul_f32 v62, s68, v62
    v_mul_f32 v63, s68, v63
    v_exp_f32 v82, v82
    v_exp_f32 v60, v60
    v_exp_f32 v61, v61
    v_exp_f32 v62, v62
    v_exp_f32 v63, v63
    v_mov_b32 v52, v86
    v_readlane_b32 s72, v82, 0
    v_readlane_b32 s73, v82, 1
    v_readlane_b32 s74, v82, 2
    v_readlane_b32 s75, v82, 3
    v_add_f32 v88, v60, v61
    v_add_f32 v89, v62, v63
    v_cvt_pk_bf16_f32 v80, v60, v61
    v_cvt_pk_bf16_f32 v81, v62, v63
    v_add_f32 v88, v88, v89
    v_fma_f32 v56, v56, v82, v88
    v_pk_mul_f32 v[20:21], v[20:21], s[72:73]
    v_pk_mul_f32 v[22:23], v[22:23], s[74:75]
    v_pk_mul_f32 v[24:25], v[24:25], s[72:73]
    v_pk_mul_f32 v[26:27], v[26:27], s[74:75]
    v_pk_mul_f32 v[28:29], v[28:29], s[72:73]
    v_pk_mul_f32 v[30:31], v[30:31], s[74:75]
    v_pk_mul_f32 v[32:33], v[32:33], s[72:73]
    v_pk_mul_f32 v[34:35], v[34:35], s[74:75]
    v_pk_mul_f32 v[36:37], v[36:37], s[72:73]
    v_pk_mul_f32 v[38:39], v[38:39], s[74:75]
    v_pk_mul_f32 v[40:41], v[40:41], s[72:73]
    v_pk_mul_f32 v[42:43], v[42:43], s[74:75]
    v_pk_mul_f32 v[44:45], v[44:45], s[72:73]
    v_pk_mul_f32 v[46:47], v[46:47], s[74:75]
    v_pk_mul_f32 v[48:49], v[48:49], s[72:73]
    v_pk_mul_f32 v[50:51], v[50:51], s[74:75]
    s_nop 2
    s_setpc_b64 s[84:85]
.LstK_204:
    ds_write_b128 v53, v[204:207] offset:0
    v_xor_b32 v85, 64, v53
    ds_write_b128 v85, v[208:211] offset:1024
    v_xor_b32 v86, 128, v53
    ds_write_b128 v86, v[212:215] offset:2048
    v_xor_b32 v87, 192, v53
    ds_write_b128 v87, v[216:219] offset:3072
    ds_read_b128 v[204:207], v54
    v_xor_b32 v89, 64, v54
    ds_read_b128 v[208:211], v89
    v_xor_b32 v90, 128, v54
    ds_read_b128 v[212:215], v90
    v_xor_b32 v91, 192, v54
    ds_read_b128 v[216:219], v91
    s_nop 1
.LqkA_204:
    s_waitcnt lgkmcnt(0)
    v_mfma_f32_16x16x32_bf16 v[60:63], v[204:207], v[4:7], 0
    v_mfma_f32_16x16x32_bf16 v[60:63], v[208:211], v[8:11], v[60:63]
    v_mfma_f32_16x16x32_bf16 v[60:63], v[212:215], v[12:15], v[60:63]
    v_mfma_f32_16x16x32_bf16 v[60:63], v[216:219], v[16:19], v[60:63]
    s_nop 8
    v_cvt_pk_bf16_f32 v84, v60, v61
    v_cvt_pk_bf16_f32 v85, v62, v63
    v_lshlrev_b32 v60, 16, v84
    v_and_b32 v61, s69, v84
    v_lshlrev_b32 v62, 16, v85
    v_and_b32 v63, s69, v85
    v_mul_f32 v60, s67, v60
    v_mul_f32 v61, s67, v61
    v_mul_f32 v62, s67, v62
    v_mul_f32 v63, s67, v63
    v_cvt_pk_bf16_f32 v84, v60, v61
    v_cvt_pk_bf16_f32 v85, v62, v63
    v_lshlrev_b32 v60, 16, v84
    v_and_b32 v61, s69, v84
    v_lshlrev_b32 v62, 16, v85
    v_and_b32 v63, s69, v85
    v_max3_f32 v86, v60, v61, v62
    v_max3_f32 v86, v86, v63, v52
    v_mov_b32 v87, v86
    s_nop 1
    v_permlane32_swap_b32 v86, v87
    v_max_f32 v86, v86, v87
    v_mov_b32 v87, v86
    s_nop 1
    v_permlane16_swap_b32 v86, v87
    v_max_f32 v86, v86, v87
    v_sub_f32 v82, v52, v86
    v_sub_f32 v60, v60, v86
    v_sub_f32 v61, v61, v86
    v_sub_f32 v62, v62, v86
    v_sub_f32 v63, v63, v86
    v_mul_f32 v82, s68, v82
    v_mul_f32 v60, s68, v60
    v_mul_f32 v61, s68, v61
    v_mul_f32 v62, s68, v62
    v_mul_f32 v63, s68, v63
    v_exp_f32 v82, v82
    v_exp_f32 v60, v60
    v_exp_f32 v61, v61
    v_exp_f32 v62, v62
    v_exp_f32 v63, v63
    v_mov_b32 v52, v86
    v_readlane_b32 s72, v82, 0
    v_readlane_b32 s73, v82, 1
    v_readlane_b32 s74, v82, 2
    v_readlane_b32 s75, v82, 3
    v_add_f32 v88, v60, v61
    v_add_f32 v89, v62, v63
    v_cvt_pk_bf16_f32 v80, v60, v61
    v_cvt_pk_bf16_f32 v81, v62, v63
    v_add_f32 v88, v88, v89
    v_fma_f32 v56, v56, v82, v88
    v_pk_mul_f32 v[20:21], v[20:21], s[72:73]
    v_pk_mul_f32 v[22:23], v[22:23], s[74:75]
    v_pk_mul_f32 v[24:25], v[24:25], s[72:73]
    v_pk_mul_f32 v[26:27], v[26:27], s[74:75]
    v_pk_mul_f32 v[28:29], v[28:29], s[72:73]
    v_pk_mul_f32 v[30:31], v[30:31], s[74:75]
    v_pk_mul_f32 v[32:33], v[32:33], s[72:73]
    v_pk_mul_f32 v[34:35], v[34:35], s[74:75]
    v_pk_mul_f32 v[36:37], v[36:37], s[72:73]
    v_pk_mul_f32 v[38:39], v[38:39], s[74:75]
    v_pk_mul_f32 v[40:41], v[40:41], s[72:73]
    v_pk_mul_f32 v[42:43], v[42:43], s[74:75]
    v_pk_mul_f32 v[44:45], v[44:45], s[72:73]
    v_pk_mul_f32 v[46:47], v[46:47], s[74:75]
    v_pk_mul_f32 v[48:49], v[48:49], s[72:73]
    v_pk_mul_f32 v[50:51], v[50:51], s[74:75]
    s_nop 2
    s_setpc_b64 s[84:85]
.LstK_220:
    ds_write_b128 v53, v[220:223] offset:0
    v_xor_b32 v85, 64, v53
    ds_write_b128 v85, v[224:227] offset:1024
    v_xor_b32 v86, 128, v53
    ds_write_b128 v86, v[228:231] offset:2048
    v_xor_b32 v87, 192, v53
    ds_write_b128 v87, v[232:235] offset:3072
    ds_read_b128 v[220:223], v54
    v_xor_b32 v89, 64, v54
    ds_read_b128 v[224:227], v89
    v_xor_b32 v90, 128, v54
    ds_read_b128 v[228:231], v90
    v_xor_b32 v91, 192, v54
    ds_read_b128 v[232:235], v91
    s_nop 1
.LqkA_220:
    s_waitcnt lgkmcnt(0)
    v_mfma_f32_16x16x32_bf16 v[60:63], v[220:223], v[4:7], 0
    v_mfma_f32_16x16x32_bf16 v[60:63], v[224:227], v[8:11], v[60:63]
    v_mfma_f32_16x16x32_bf16 v[60:63], v[228:231], v[12:15], v[60:63]
    v_mfma_f32_16x16x32_bf16 v[60:63], v[232:235], v[16:19], v[60:63]
    s_nop 8
    v_cvt_pk_bf16_f32 v84, v60, v61
    v_cvt_pk_bf16_f32 v85, v62, v63
    v_lshlrev_b32 v60, 16, v84
    v_and_b32 v61, s69, v84
    v_lshlrev_b32 v62, 16, v85
    v_and_b32 v63, s69, v85
    v_mul_f32 v60, s67, v60
    v_mul_f32 v61, s67, v61
    v_mul_f32 v62, s67, v62
    v_mul_f32 v63, s67, v63
    v_cvt_pk_bf16_f32 v84, v60, v61
    v_cvt_pk_bf16_f32 v85, v62, v63
    v_lshlrev_b32 v60, 16, v84
    v_and_b32 v61, s69, v84
    v_lshlrev_b32 v62, 16, v85
    v_and_b32 v63, s69, v85
    v_max3_f32 v86, v60, v61, v62
    v_max3_f32 v86, v86, v63, v52
    v_mov_b32 v87, v86
    s_nop 1
    v_permlane32_swap_b32 v86, v87
    v_max_f32 v86, v86, v87
    v_mov_b32 v87, v86
    s_nop 1
    v_permlane16_swap_b32 v86, v87
    v_max_f32 v86, v86, v87
    v_sub_f32 v82, v52, v86
    v_sub_f32 v60, v60, v86
    v_sub_f32 v61, v61, v86
    v_sub_f32 v62, v62, v86
    v_sub_f32 v63, v63, v86
    v_mul_f32 v82, s68, v82
    v_mul_f32 v60, s68, v60
    v_mul_f32 v61, s68, v61
    v_mul_f32 v62, s68, v62
    v_mul_f32 v63, s68, v63
    v_exp_f32 v82, v82
    v_exp_f32 v60, v60
    v_exp_f32 v61, v61
    v_exp_f32 v62, v62
    v_exp_f32 v63, v63
    v_mov_b32 v52, v86
    v_readlane_b32 s72, v82, 0
    v_readlane_b32 s73, v82, 1
    v_readlane_b32 s74, v82, 2
    v_readlane_b32 s75, v82, 3
    v_add_f32 v88, v60, v61
    v_add_f32 v89, v62, v63
    v_cvt_pk_bf16_f32 v80, v60, v61
    v_cvt_pk_bf16_f32 v81, v62, v63
    v_add_f32 v88, v88, v89
    v_fma_f32 v56, v56, v82, v88
    v_pk_mul_f32 v[20:21], v[20:21], s[72:73]
    v_pk_mul_f32 v[22:23], v[22:23], s[74:75]
    v_pk_mul_f32 v[24:25], v[24:25], s[72:73]
    v_pk_mul_f32 v[26:27], v[26:27], s[74:75]
    v_pk_mul_f32 v[28:29], v[28:29], s[72:73]
    v_pk_mul_f32 v[30:31], v[30:31], s[74:75]
    v_pk_mul_f32 v[32:33], v[32:33], s[72:73]
    v_pk_mul_f32 v[34:35], v[34:35], s[74:75]
    v_pk_mul_f32 v[36:37], v[36:37], s[72:73]
    v_pk_mul_f32 v[38:39], v[38:39], s[74:75]
    v_pk_mul_f32 v[40:41], v[40:41], s[72:73]
    v_pk_mul_f32 v[42:43], v[42:43], s[74:75]
    v_pk_mul_f32 v[44:45], v[44:45], s[72:73]
    v_pk_mul_f32 v[46:47], v[46:47], s[74:75]
    v_pk_mul_f32 v[48:49], v[48:49], s[72:73]
    v_pk_mul_f32 v[50:51], v[50:51], s[74:75]
    s_nop 2
    s_setpc_b64 s[84:85]
.LstK_92:
    ds_write_b128 v53, v[92:95] offset:0
    v_xor_b32 v85, 64, v53
    ds_write_b128 v85, v[96:99] offset:1024
    v_xor_b32 v86, 128, v53
    ds_write_b128 v86, v[100:103] offset:2048
    v_xor_b32 v87, 192, v53
    ds_write_b128 v87, v[104:107] offset:3072
    ds_read_b128 v[92:95], v54
    v_xor_b32 v89, 64, v54
    ds_read_b128 v[96:99], v89
    v_xor_b32 v90, 128, v54
    ds_read_b128 v[100:103], v90
    v_xor_b32 v91, 192, v54
    ds_read_b128 v[104:107], v91
    s_nop 1
.LqkA_92:
    s_waitcnt lgkmcnt(0)
    v_mfma_f32_16x16x32_bf16 v[60:63], v[92:95], v[4:7], 0
    v_mfma_f32_16x16x32_bf16 v[60:63], v[96:99], v[8:11], v[60:63]
    v_mfma_f32_16x16x32_bf16 v[60:63], v[100:103], v[12:15], v[60:63]
    v_mfma_f32_16x16x32_bf16 v[60:63], v[104:107], v[16:19], v[60:63]
    s_nop 8
    v_cvt_pk_bf16_f32 v84, v60, v61
    v_cvt_pk_bf16_f32 v85, v62, v63
    v_lshlrev_b32 v60, 16, v84
    v_and_b32 v61, s69, v84
    v_lshlrev_b32 v62, 16, v85
    v_and_b32 v63, s69, v85
    v_mul_f32 v60, s67, v60
    v_mul_f32 v61, s67, v61
    v_mul_f32 v62, s67, v62
    v_mul_f32 v63, s67, v63
    v_cvt_pk_bf16_f32 v84, v60, v61
    v_cvt_pk_bf16_f32 v85, v62, v63
    v_lshlrev_b32 v60, 16, v84
    v_and_b32 v61, s69, v84
    v_lshlrev_b32 v62, 16, v85
    v_and_b32 v63, s69, v85
    v_max3_f32 v86, v60, v61, v62
    v_max3_f32 v86, v86, v63, v52
    v_mov_b32 v87, v86
    s_nop 1
    v_permlane32_swap_b32 v86, v87
    v_max_f32 v86, v86, v87
    v_mov_b32 v87, v86
    s_nop 1
    v_permlane16_swap_b32 v86, v87
    v_max_f32 v86, v86, v87
    v_sub_f32 v82, v52, v86
    v_sub_f32 v60, v60, v86
    v_sub_f32 v61, v61, v86
    v_sub_f32 v62, v62, v86
    v_sub_f32 v63, v63, v86
    v_mul_f32 v82, s68, v82
    v_mul_f32 v60, s68, v60
    v_mul_f32 v61, s68, v61
    v_mul_f32 v62, s68, v62
    v_mul_f32 v63, s68, v63
    v_exp_f32 v82, v82
    v_exp_f32 v60, v60
    v_exp_f32 v61, v61
    v_exp_f32 v62, v62
    v_exp_f32 v63, v63
    v_mov_b32 v52, v86
    v_readlane_b32 s72, v82, 0
    v_readlane_b32 s73, v82, 1
    v_readlane_b32 s74, v82, 2
    v_readlane_b32 s75, v82, 3
    v_add_f32 v88, v60, v61
    v_add_f32 v89, v62, v63
    v_cvt_pk_bf16_f32 v80, v60, v61
    v_cvt_pk_bf16_f32 v81, v62, v63
    v_add_f32 v88, v88, v89
    v_fma_f32 v56, v56, v82, v88
    v_pk_mul_f32 v[20:21], v[20:21], s[72:73]
    v_pk_mul_f32 v[22:23], v[22:23], s[74:75]
    v_pk_mul_f32 v[24:25], v[24:25], s[72:73]
    v_pk_mul_f32 v[26:27], v[26:27], s[74:75]
    v_pk_mul_f32 v[28:29], v[28:29], s[72:73]
    v_pk_mul_f32 v[30:31], v[30:31], s[74:75]
    v_pk_mul_f32 v[32:33], v[32:33], s[72:73]
    v_pk_mul_f32 v[34:35], v[34:35], s[74:75]
    v_pk_mul_f32 v[36:37], v[36:37], s[72:73]
    v_pk_mul_f32 v[38:39], v[38:39], s[74:75]
    v_pk_mul_f32 v[40:41], v[40:41], s[72:73]
    v_pk_mul_f32 v[42:43], v[42:43], s[74:75]
    v_pk_mul_f32 v[44:45], v[44:45], s[72:73]
    v_pk_mul_f32 v[46:47], v[46:47], s[74:75]
    v_pk_mul_f32 v[48:49], v[48:49], s[72:73]
    v_pk_mul_f32 v[50:51], v[50:51], s[74:75]
    s_nop 2
    s_setpc_b64 s[84:85]
.LstK_124:
    ds_write_b128 v53, v[124:127] offset:0
    v_xor_b32 v85, 64, v53
    ds_write_b128 v85, v[128:131] offset:1024
    v_xor_b32 v86, 128, v53
    ds_write_b128 v86, v[132:135] offset:2048
    v_xor_b32 v87, 192, v53
    ds_write_b128 v87, v[136:139] offset:3072
    ds_read_b128 v[124:127], v54
    v_xor_b32 v89, 64, v54
    ds_read_b128 v[128:131], v89
    v_xor_b32 v90, 128, v54
    ds_read_b128 v[132:135], v90
    v_xor_b32 v91, 192, v54
    ds_read_b128 v[136:139], v91
    s_nop 1
.LqkA_124:
    s_waitcnt lgkmcnt(0)
    v_mfma_f32_16x16x32_bf16 v[60:63], v[124:127], v[4:7], 0
    v_mfma_f32_16x16x32_bf16 v[60:63], v[128:131], v[8:11], v[60:63]
    v_mfma_f32_16x16x32_bf16 v[60:63], v[132:135], v[12:15], v[60:63]
    v_mfma_f32_16x16x32_bf16 v[60:63], v[136:139], v[16:19], v[60:63]
    s_nop 8
    v_cvt_pk_bf16_f32 v84, v60, v61
    v_cvt_pk_bf16_f32 v85, v62, v63
    v_lshlrev_b32 v60, 16, v84
    v_and_b32 v61, s69, v84
    v_lshlrev_b32 v62, 16, v85
    v_and_b32 v63, s69, v85
    v_mul_f32 v60, s67, v60
    v_mul_f32 v61, s67, v61
    v_mul_f32 v62, s67, v62
    v_mul_f32 v63, s67, v63
    v_cvt_pk_bf16_f32 v84, v60, v61
    v_cvt_pk_bf16_f32 v85, v62, v63
    v_lshlrev_b32 v60, 16, v84
    v_and_b32 v61, s69, v84
    v_lshlrev_b32 v62, 16, v85
    v_and_b32 v63, s69, v85
    v_max3_f32 v86, v60, v61, v62
    v_max3_f32 v86, v86, v63, v52
    v_mov_b32 v87, v86
    s_nop 1
    v_permlane32_swap_b32 v86, v87
    v_max_f32 v86, v86, v87
    v_mov_b32 v87, v86
    s_nop 1
    v_permlane16_swap_b32 v86, v87
    v_max_f32 v86, v86, v87
    v_sub_f32 v82, v52, v86
    v_sub_f32 v60, v60, v86
    v_sub_f32 v61, v61, v86
    v_sub_f32 v62, v62, v86
    v_sub_f32 v63, v63, v86
    v_mul_f32 v82, s68, v82
    v_mul_f32 v60, s68, v60
    v_mul_f32 v61, s68, v61
    v_mul_f32 v62, s68, v62
    v_mul_f32 v63, s68, v63
    v_exp_f32 v82, v82
    v_exp_f32 v60, v60
    v_exp_f32 v61, v61
    v_exp_f32 v62, v62
    v_exp_f32 v63, v63
    v_mov_b32 v52, v86
    v_readlane_b32 s72, v82, 0
    v_readlane_b32 s73, v82, 1
    v_readlane_b32 s74, v82, 2
    v_readlane_b32 s75, v82, 3
    v_add_f32 v88, v60, v61
    v_add_f32 v89, v62, v63
    v_cvt_pk_bf16_f32 v80, v60, v61
    v_cvt_pk_bf16_f32 v81, v62, v63
    v_add_f32 v88, v88, v89
    v_fma_f32 v56, v56, v82, v88
    v_pk_mul_f32 v[20:21], v[20:21], s[72:73]
    v_pk_mul_f32 v[22:23], v[22:23], s[74:75]
    v_pk_mul_f32 v[24:25], v[24:25], s[72:73]
    v_pk_mul_f32 v[26:27], v[26:27], s[74:75]
    v_pk_mul_f32 v[28:29], v[28:29], s[72:73]
    v_pk_mul_f32 v[30:31], v[30:31], s[74:75]
    v_pk_mul_f32 v[32:33], v[32:33], s[72:73]
    v_pk_mul_f32 v[34:35], v[34:35], s[74:75]
    v_pk_mul_f32 v[36:37], v[36:37], s[72:73]
    v_pk_mul_f32 v[38:39], v[38:39], s[74:75]
    v_pk_mul_f32 v[40:41], v[40:41], s[72:73]
    v_pk_mul_f32 v[42:43], v[42:43], s[74:75]
    v_pk_mul_f32 v[44:45], v[44:45], s[72:73]
    v_pk_mul_f32 v[46:47], v[46:47], s[74:75]
    v_pk_mul_f32 v[48:49], v[48:49], s[72:73]
    v_pk_mul_f32 v[50:51], v[50:51], s[74:75]
    s_nop 2
    s_setpc_b64 s[84:85]
.LvwA_92:
    v_add_u32 v84, s100, v55
    v_xor_b32 v85, 0x80, v84
    ds_write_b128 v84, v[92:95] offset:0
    ds_write_b128 v85, v[96:99] offset:1024
    ds_write_b128 v84, v[100:103] offset:2048
    ds_write_b128 v85, v[104:107] offset:3072
    s_branch .LpvA
.LvwA_108:
    v_add_u32 v84, s100, v55
    v_xor_b32 v85, 0x80, v84
    ds_write_b128 v84, v[108:111] offset:0
    ds_write_b128 v85, v[112:115] offset:1024
    ds_write_b128 v84, v[116:119] offset:2048
    ds_write_b128 v85, v[120:123] offset:3072
    s_branch .LpvA
.LvwA_124:
    v_add_u32 v84, s100, v55
    v_xor_b32 v85, 0x80, v84
    ds_write_b128 v84, v[124:127] offset:0
    ds_write_b128 v85, v[128:131] offset:1024
    ds_write_b128 v84, v[132:135] offset:2048
    ds_write_b128 v85, v[136:139] offset:3072
    s_branch .LpvA
.LvwA_140:
    v_add_u32 v84, s100, v55
    v_xor_b32 v85, 0x80, v84
    ds_write_b128 v84, v[140:143] offset:0
    ds_write_b128 v85, v[144:147] offset:1024
    ds_write_b128 v84, v[148:151] offset:2048
    ds_write_b128 v85, v[152:155] offset:3072
    s_branch .LpvA
.LvwA_236:
    v_add_u32 v84, s100, v55
    v_xor_b32 v85, 0x80, v84
    ds_write_b128 v84, v[236:239] offset:0
    ds_write_b128 v85, v[240:243] offset:1024
    ds_write_b128 v84, v[244:247] offset:2048
    ds_write_b128 v85, v[248:251] offset:3072
    s_branch .LpvA
.LvwA_156:
    v_add_u32 v84, s100, v55
    v_xor_b32 v85, 0x80, v84
    ds_write_b128 v84, v[156:159] offset:0
    ds_write_b128 v85, v[160:163] offset:1024
    ds_write_b128 v84, v[164:167] offset:2048
    ds_write_b128 v85, v[168:171] offset:3072
    s_branch .LpvA
.LvwA_188:
    v_add_u32 v84, s100, v55
    v_xor_b32 v85, 0x80, v84
    ds_write_b128 v84, v[188:191] offset:0
    ds_write_b128 v85, v[192:195] offset:1024
    ds_write_b128 v84, v[196:199] offset:2048
    ds_write_b128 v85, v[200:203] offset:3072
    s_branch .LpvA
.LpvA:
    v_add_u32 v84, s100, v57
    ds_read_b64_tr_b16 v[64:65], v84
    v_xor_b32 v86, 32, v84
    ds_read_b64_tr_b16 v[66:67], v86
    v_xor_b32 v87, 64, v84
    ds_read_b64_tr_b16 v[68:69], v87
    v_xor_b32 v88, 96, v84
    ds_read_b64_tr_b16 v[70:71], v88
    v_xor_b32 v85, 128, v84
    ds_read_b64_tr_b16 v[72:73], v85
    v_xor_b32 v86, 160, v84
    ds_read_b64_tr_b16 v[74:75], v86
    v_xor_b32 v87, 192, v84
    ds_read_b64_tr_b16 v[76:77], v87
    v_xor_b32 v88, 224, v84
    ds_read_b64_tr_b16 v[78:79], v88
    s_waitcnt lgkmcnt(0)
    v_mfma_f32_16x16x16_bf16 v[20:23], v[80:81], v[64:65], v[20:23]
    v_mfma_f32_16x16x16_bf16 v[24:27], v[80:81], v[66:67], v[24:27]
    v_mfma_f32_16x16x16_bf16 v[28:31], v[80:81], v[68:69], v[28:31]
    v_mfma_f32_16x16x16_bf16 v[32:35], v[80:81], v[70:71], v[32:35]
    v_mfma_f32_16x16x16_bf16 v[36:39], v[80:81], v[72:73], v[36:39]
    v_mfma_f32_16x16x16_bf16 v[40:43], v[80:81], v[74:75], v[40:43]
    v_mfma_f32_16x16x16_bf16 v[44:47], v[80:81], v[76:77], v[44:47]
    v_mfma_f32_16x16x16_bf16 v[48:51], v[80:81], v[78:79], v[48:51]
    s_nop 8
    s_setpc_b64 s[84:85]
.LwcombA:
    v_mov_b32 v84, v56
    s_nop 1
    v_permlane32_swap_b32 v56, v84
    v_add_f32 v56, v56, v84
    v_mov_b32 v84, v56
    s_nop 1
    v_permlane16_swap_b32 v56, v84
    v_add_f32 v56, v56, v84
    v_and_b32 v84, 63, v0
    s_lshl_b32 s61, s60, 2
    v_lshlrev_b32 v85, 5, v84
    v_add_u32 v85, s61, v85
    v_lshlrev_b32 v86, 2, v84
    v_add_u32 v86, s99, v86
    s_mov_b64 exec, 15
    ds_write_b32 v85, v52 offset:4096
    ds_write_b32 v85, v56 offset:4608
    s_mov_b64 exec, 0xffff
    ds_write_b32 v86, v20 offset:8192
    ds_write_b32 v86, v21 offset:8704
    ds_write_b32 v86, v22 offset:9216
    ds_write_b32 v86, v23 offset:9728
    ds_write_b32 v86, v24 offset:8256
    ds_write_b32 v86, v25 offset:8768
    ds_write_b32 v86, v26 offset:9280
    ds_write_b32 v86, v27 offset:9792
    ds_write_b32 v86, v28 offset:8320
    ds_write_b32 v86, v29 offset:8832
    ds_write_b32 v86, v30 offset:9344
    ds_write_b32 v86, v31 offset:9856
    ds_write_b32 v86, v32 offset:8384
    ds_write_b32 v86, v33 offset:8896
    ds_write_b32 v86, v34 offset:9408
    ds_write_b32 v86, v35 offset:9920
    ds_write_b32 v86, v36 offset:8448
    ds_write_b32 v86, v37 offset:8960
    ds_write_b32 v86, v38 offset:9472
    ds_write_b32 v86, v39 offset:9984
    ds_write_b32 v86, v40 offset:8512
    ds_write_b32 v86, v41 offset:9024
    ds_write_b32 v86, v42 offset:9536
    ds_write_b32 v86, v43 offset:10048
    ds_write_b32 v86, v44 offset:8576
    ds_write_b32 v86, v45 offset:9088
    ds_write_b32 v86, v46 offset:9600
    ds_write_b32 v86, v47 offset:10112
    ds_write_b32 v86, v48 offset:8640
    ds_write_b32 v86, v49 offset:9152
    ds_write_b32 v86, v50 offset:9664
    ds_write_b32 v86, v51 offset:10176
    s_mov_b64 exec, -1
    s_waitcnt lgkmcnt(0)
    s_setpc_b64 s[84:85]
.Ltouch0:
    s_and_b32 s61, s63, 3
    v_and_b32 v8, 63, v0
    v_lshlrev_b32 v9, 7, v8
    s_lshl_b32 s70, s59, 17
    s_lshl_b32 s71, s61, 15
    s_add_u32 s70, s70, s71
    buffer_load_dword v10, v9, s[36:39], s70 offen
    s_add_u32 s70, s70, 8192
    buffer_load_dword v10, v9, s[36:39], s70 offen
    s_add_u32 s70, s70, 8192
    buffer_load_dword v10, v9, s[36:39], s70 offen
    s_add_u32 s70, s70, 8192
    buffer_load_dword v10, v9, s[36:39], s70 offen
    s_add_u32 s70, s70, 8192
    v_lshrrev_b32 v9, 1, v8
    v_lshlrev_b32 v9, 13, v9
    v_and_b32 v8, 1, v8
    v_lshl_add_u32 v9, v8, 7, v9
    s_lshl_b32 s70, s59, 8
    s_lshl_b32 s71, s61, 20
    s_add_u32 s70, s70, s71
    buffer_load_dword v10, v9, s[24:27], s70 offen
    s_add_u32 s70, s70, 262144
    buffer_load_dword v10, v9, s[24:27], s70 offen
    s_add_u32 s70, s70, 262144
    buffer_load_dword v10, v9, s[24:27], s70 offen
    s_add_u32 s70, s70, 262144
    buffer_load_dword v10, v9, s[24:27], s70 offen
    s_add_u32 s70, s70, 262144
    s_setpc_b64 s[86:87]
.Ltouch1:
    s_and_b32 s61, s63, 3
    v_and_b32 v8, 63, v0
    v_lshlrev_b32 v9, 7, v8
    s_lshl_b32 s70, s59, 17
    s_lshl_b32 s71, s61, 15
    s_add_u32 s70, s70, s71
    buffer_load_dword v10, v9, s[36:39], s70 offen
    s_add_u32 s70, s70, 8192
    buffer_load_dword v10, v9, s[36:39], s70 offen
    s_add_u32 s70, s70, 8192
    buffer_load_dword v10, v9, s[36:39], s70 offen
    s_add_u32 s70, s70, 8192
    buffer_load_dword v10, v9, s[36:39], s70 offen
    s_add_u32 s70, s70, 8192
    s_setpc_b64 s[86:87]
.LwcombB:
    v_mov_b32 v84, v52
    v_mov_b32 v85, v52
    s_nop 1
    v_permlane32_swap_b32 v84, v85
    v_max_f32 v84, v84, v85
    v_mov_b32 v85, v84
    s_nop 1
    v_permlane16_swap_b32 v84, v85
    v_max_f32 v84, v84, v85
    v_sub_f32 v86, v52, v84
    v_mul_f32 v86, s68, v86
    v_exp_f32 v86, v86
    v_mov_b32 v52, v84
    v_mul_f32 v56, v56, v86
    v_mul_f32 v20, v20, v86
    v_mul_f32 v21, v21, v86
    v_mul_f32 v22, v22, v86
    v_mul_f32 v23, v23, v86
    v_mul_f32 v24, v24, v86
    v_mul_f32 v25, v25, v86
    v_mul_f32 v26, v26, v86
    v_mul_f32 v27, v27, v86
    v_mov_b32 v60, v56
    v_mov_b32 v61, v20
    v_mov_b32 v62, v21
    v_mov_b32 v63, v22
    v_mov_b32 v64, v23
    v_mov_b32 v65, v24
    v_mov_b32 v66, v25
    v_mov_b32 v67, v26
    v_mov_b32 v68, v27
    v_permlane32_swap_b32 v56, v60
    v_permlane32_swap_b32 v20, v61
    v_permlane32_swap_b32 v21, v62
    v_permlane32_swap_b32 v22, v63
    v_permlane32_swap_b32 v23, v64
    v_permlane32_swap_b32 v24, v65
    v_permlane32_swap_b32 v25, v66
    v_permlane32_swap_b32 v26, v67
    v_permlane32_swap_b32 v27, v68
    v_add_f32 v56, v56, v60
    v_add_f32 v20, v20, v61
    v_add_f32 v21, v21, v62
    v_add_f32 v22, v22, v63
    v_add_f32 v23, v23, v64
    v_add_f32 v24, v24, v65
    v_add_f32 v25, v25, v66
    v_add_f32 v26, v26, v67
    v_add_f32 v27, v27, v68
    v_mov_b32 v60, v56
    v_mov_b32 v61, v20
    v_mov_b32 v62, v21
    v_mov_b32 v63, v22
    v_mov_b32 v64, v23
    v_mov_b32 v65, v24
    v_mov_b32 v66, v25
    v_mov_b32 v67, v26
    v_mov_b32 v68, v27
    v_permlane16_swap_b32 v56, v60
    v_permlane16_swap_b32 v20, v61
    v_permlane16_swap_b32 v21, v62
    v_permlane16_swap_b32 v22, v63
    v_permlane16_swap_b32 v23, v64
    v_permlane16_swap_b32 v24, v65
    v_permlane16_swap_b32 v25, v66
    v_permlane16_swap_b32 v26, v67
    v_permlane16_swap_b32 v27, v68
    v_add_f32 v56, v56, v60
    v_add_f32 v20, v20, v61
    v_add_f32 v21, v21, v62
    v_add_f32 v22, v22, v63
    v_add_f32 v23, v23, v64
    v_add_f32 v24, v24, v65
    v_add_f32 v25, v25, v66
    v_add_f32 v26, v26, v67
    v_add_f32 v27, v27, v68
    s_lshl_b32 s61, s60, 2
    v_mov_b32 v84, s61
    ds_write_b32 v84, v52 offset:4096
    ds_write_b32 v84, v56 offset:4608
    v_and_b32 v85, 15, v0
    v_lshlrev_b32 v85, 5, v85
    v_add_u32 v85, s99, v85
    ds_write_b128 v85, v[20:23] offset:8192
    ds_write_b128 v85, v[24:27] offset:8208
    s_waitcnt lgkmcnt(0)
    s_setpc_b64 s[84:85]
.Lgemv_4:
    v_perm_b32 v88, v8, v4, s65
    v_perm_b32 v89, v8, v4, s66
    v_dot2_f32_bf16 v68, v88, v76, v68
    v_dot2_f32_bf16 v69, v89, v76, v69
    v_perm_b32 v90, v9, v5, s65
    v_perm_b32 v91, v9, v5, s66
    v_dot2_f32_bf16 v70, v90, v76, v70
    v_dot2_f32_bf16 v71, v91, v76, v71
    v_perm_b32 v88, v10, v6, s65
    v_perm_b32 v89, v10, v6, s66
    v_dot2_f32_bf16 v72, v88, v76, v72
    v_dot2_f32_bf16 v73, v89, v76, v73
    v_perm_b32 v90, v11, v7, s65
    v_perm_b32 v91, v11, v7, s66
    v_dot2_f32_bf16 v74, v90, v76, v74
    v_dot2_f32_bf16 v75, v91, v76, v75
    v_perm_b32 v88, v16, v12, s65
    v_perm_b32 v89, v16, v12, s66
    v_dot2_f32_bf16 v68, v88, v77, v68
    v_dot2_f32_bf16 v69, v89, v77, v69
    v_perm_b32 v90, v17, v13, s65
    v_perm_b32 v91, v17, v13, s66
    v_dot2_f32_bf16 v70, v90, v77, v70
    v_dot2_f32_bf16 v71, v91, v77, v71
    v_perm_b32 v88, v18, v14, s65
    v_perm_b32 v89, v18, v14, s66
    v_dot2_f32_bf16 v72, v88, v77, v72
    v_dot2_f32_bf16 v73, v89, v77, v73
    v_perm_b32 v90, v19, v15, s65
    v_perm_b32 v91, v19, v15, s66
    v_dot2_f32_bf16 v74, v90, v77, v74
    v_dot2_f32_bf16 v75, v91, v77, v75
    v_perm_b32 v88, v24, v20, s65
    v_perm_b32 v89, v24, v20, s66
    v_dot2_f32_bf16 v68, v88, v78, v68
    v_dot2_f32_bf16 v69, v89, v78, v69
    v_perm_b32 v90, v25, v21, s65
    v_perm_b32 v91, v25, v21, s66
    v_dot2_f32_bf16 v70, v90, v78, v70
    v_dot2_f32_bf16 v71, v91, v78, v71
    v_perm_b32 v88, v26, v22, s65
    v_perm_b32 v89, v26, v22, s66
    v_dot2_f32_bf16 v72, v88, v78, v72
    v_dot2_f32_bf16 v73, v89, v78, v73
    v_perm_b32 v90, v27, v23, s65
    v_perm_b32 v91, v27, v23, s66
    v_dot2_f32_bf16 v74, v90, v78, v74
    v_dot2_f32_bf16 v75, v91, v78, v75
    v_perm_b32 v88, v32, v28, s65
    v_perm_b32 v89, v32, v28, s66
    v_dot2_f32_bf16 v68, v88, v79, v68
    v_dot2_f32_bf16 v69, v89, v79, v69
    v_perm_b32 v90, v33, v29, s65
    v_perm_b32 v91, v33, v29, s66
    v_dot2_f32_bf16 v70, v90, v79, v70
    v_dot2_f32_bf16 v71, v91, v79, v71
    v_perm_b32 v88, v34, v30, s65
    v_perm_b32 v89, v34, v30, s66
    v_dot2_f32_bf16 v72, v88, v79, v72
    v_dot2_f32_bf16 v73, v89, v79, v73
    v_perm_b32 v90, v35, v31, s65
    v_perm_b32 v91, v35, v31, s66
    v_dot2_f32_bf16 v74, v90, v79, v74
    v_dot2_f32_bf16 v75, v91, v79, v75
    v_perm_b32 v88, v40, v36, s65
    v_perm_b32 v89, v40, v36, s66
    v_dot2_f32_bf16 v68, v88, v80, v68
    v_dot2_f32_bf16 v69, v89, v80, v69
    v_perm_b32 v90, v41, v37, s65
    v_perm_b32 v91, v41, v37, s66
    v_dot2_f32_bf16 v70, v90, v80, v70
    v_dot2_f32_bf16 v71, v91, v80, v71
    v_perm_b32 v88, v42, v38, s65
    v_perm_b32 v89, v42, v38, s66
    v_dot2_f32_bf16 v72, v88, v80, v72
    v_dot2_f32_bf16 v73, v89, v80, v73
    v_perm_b32 v90, v43, v39, s65
    v_perm_b32 v91, v43, v39, s66
    v_dot2_f32_bf16 v74, v90, v80, v74
    v_dot2_f32_bf16 v75, v91, v80, v75
    v_perm_b32 v88, v48, v44, s65
    v_perm_b32 v89, v48, v44, s66
    v_dot2_f32_bf16 v68, v88, v81, v68
    v_dot2_f32_bf16 v69, v89, v81, v69
    v_perm_b32 v90, v49, v45, s65
    v_perm_b32 v91, v49, v45, s66
    v_dot2_f32_bf16 v70, v90, v81, v70
    v_dot2_f32_bf16 v71, v91, v81, v71
    v_perm_b32 v88, v50, v46, s65
    v_perm_b32 v89, v50, v46, s66
    v_dot2_f32_bf16 v72, v88, v81, v72
    v_dot2_f32_bf16 v73, v89, v81, v73
    v_perm_b32 v90, v51, v47, s65
    v_perm_b32 v91, v51, v47, s66
    v_dot2_f32_bf16 v74, v90, v81, v74
    v_dot2_f32_bf16 v75, v91, v81, v75
    v_perm_b32 v88, v56, v52, s65
    v_perm_b32 v89, v56, v52, s66
    v_dot2_f32_bf16 v68, v88, v82, v68
    v_dot2_f32_bf16 v69, v89, v82, v69
    v_perm_b32 v90, v57, v53, s65
    v_perm_b32 v91, v57, v53, s66
    v_dot2_f32_bf16 v70, v90, v82, v70
    v_dot2_f32_bf16 v71, v91, v82, v71
    v_perm_b32 v88, v58, v54, s65
    v_perm_b32 v89, v58, v54, s66
    v_dot2_f32_bf16 v72, v88, v82, v72
    v_dot2_f32_bf16 v73, v89, v82, v73
    v_perm_b32 v90, v59, v55, s65
    v_perm_b32 v91, v59, v55, s66
    v_dot2_f32_bf16 v74, v90, v82, v74
    v_dot2_f32_bf16 v75, v91, v82, v75
    v_perm_b32 v88, v64, v60, s65
    v_perm_b32 v89, v64, v60, s66
    v_dot2_f32_bf16 v68, v88, v83, v68
    v_dot2_f32_bf16 v69, v89, v83, v69
    v_perm_b32 v90, v65, v61, s65
    v_perm_b32 v91, v65, v61, s66
    v_dot2_f32_bf16 v70, v90, v83, v70
    v_dot2_f32_bf16 v71, v91, v83, v71
    v_perm_b32 v88, v66, v62, s65
    v_perm_b32 v89, v66, v62, s66
    v_dot2_f32_bf16 v72, v88, v83, v72
    v_dot2_f32_bf16 v73, v89, v83, v73
    v_perm_b32 v90, v67, v63, s65
    v_perm_b32 v91, v67, v63, s66
    v_dot2_f32_bf16 v74, v90, v83, v74
    v_dot2_f32_bf16 v75, v91, v83, v75
    s_nop 2
    s_setpc_b64 s[86:87]
.Lgemv_92:
    v_perm_b32 v88, v96, v92, s65
    v_perm_b32 v89, v96, v92, s66
    v_dot2_f32_bf16 v68, v88, v76, v68
    v_dot2_f32_bf16 v69, v89, v76, v69
    v_perm_b32 v90, v97, v93, s65
    v_perm_b32 v91, v97, v93, s66
    v_dot2_f32_bf16 v70, v90, v76, v70
    v_dot2_f32_bf16 v71, v91, v76, v71
    v_perm_b32 v88, v98, v94, s65
    v_perm_b32 v89, v98, v94, s66
    v_dot2_f32_bf16 v72, v88, v76, v72
    v_dot2_f32_bf16 v73, v89, v76, v73
    v_perm_b32 v90, v99, v95, s65
    v_perm_b32 v91, v99, v95, s66
    v_dot2_f32_bf16 v74, v90, v76, v74
    v_dot2_f32_bf16 v75, v91, v76, v75
    v_perm_b32 v88, v104, v100, s65
    v_perm_b32 v89, v104, v100, s66
    v_dot2_f32_bf16 v68, v88, v77, v68
    v_dot2_f32_bf16 v69, v89, v77, v69
    v_perm_b32 v90, v105, v101, s65
    v_perm_b32 v91, v105, v101, s66
    v_dot2_f32_bf16 v70, v90, v77, v70
    v_dot2_f32_bf16 v71, v91, v77, v71
    v_perm_b32 v88, v106, v102, s65
    v_perm_b32 v89, v106, v102, s66
    v_dot2_f32_bf16 v72, v88, v77, v72
    v_dot2_f32_bf16 v73, v89, v77, v73
    v_perm_b32 v90, v107, v103, s65
    v_perm_b32 v91, v107, v103, s66
    v_dot2_f32_bf16 v74, v90, v77, v74
    v_dot2_f32_bf16 v75, v91, v77, v75
    v_perm_b32 v88, v112, v108, s65
    v_perm_b32 v89, v112, v108, s66
    v_dot2_f32_bf16 v68, v88, v78, v68
    v_dot2_f32_bf16 v69, v89, v78, v69
    v_perm_b32 v90, v113, v109, s65
    v_perm_b32 v91, v113, v109, s66
    v_dot2_f32_bf16 v70, v90, v78, v70
    v_dot2_f32_bf16 v71, v91, v78, v71
    v_perm_b32 v88, v114, v110, s65
    v_perm_b32 v89, v114, v110, s66
    v_dot2_f32_bf16 v72, v88, v78, v72
    v_dot2_f32_bf16 v73, v89, v78, v73
    v_perm_b32 v90, v115, v111, s65
    v_perm_b32 v91, v115, v111, s66
    v_dot2_f32_bf16 v74, v90, v78, v74
    v_dot2_f32_bf16 v75, v91, v78, v75
    v_perm_b32 v88, v120, v116, s65
    v_perm_b32 v89, v120, v116, s66
    v_dot2_f32_bf16 v68, v88, v79, v68
    v_dot2_f32_bf16 v69, v89, v79, v69
    v_perm_b32 v90, v121, v117, s65
    v_perm_b32 v91, v121, v117, s66
    v_dot2_f32_bf16 v70, v90, v79, v70
    v_dot2_f32_bf16 v71, v91, v79, v71
    v_perm_b32 v88, v122, v118, s65
    v_perm_b32 v89, v122, v118, s66
    v_dot2_f32_bf16 v72, v88, v79, v72
    v_dot2_f32_bf16 v73, v89, v79, v73
    v_perm_b32 v90, v123, v119, s65
    v_perm_b32 v91, v123, v119, s66
    v_dot2_f32_bf16 v74, v90, v79, v74
    v_dot2_f32_bf16 v75, v91, v79, v75
    v_perm_b32 v88, v128, v124, s65
    v_perm_b32 v89, v128, v124, s66
    v_dot2_f32_bf16 v68, v88, v80, v68
    v_dot2_f32_bf16 v69, v89, v80, v69
    v_perm_b32 v90, v129, v125, s65
    v_perm_b32 v91, v129, v125, s66
    v_dot2_f32_bf16 v70, v90, v80, v70
    v_dot2_f32_bf16 v71, v91, v80, v71
    v_perm_b32 v88, v130, v126, s65
    v_perm_b32 v89, v130, v126, s66
    v_dot2_f32_bf16 v72, v88, v80, v72
    v_dot2_f32_bf16 v73, v89, v80, v73
    v_perm_b32 v90, v131, v127, s65
    v_perm_b32 v91, v131, v127, s66
    v_dot2_f32_bf16 v74, v90, v80, v74
    v_dot2_f32_bf16 v75, v91, v80, v75
    v_perm_b32 v88, v136, v132, s65
    v_perm_b32 v89, v136, v132, s66
    v_dot2_f32_bf16 v68, v88, v81, v68
    v_dot2_f32_bf16 v69, v89, v81, v69
    v_perm_b32 v90, v137, v133, s65
    v_perm_b32 v91, v137, v133, s66
    v_dot2_f32_bf16 v70, v90, v81, v70
    v_dot2_f32_bf16 v71, v91, v81, v71
    v_perm_b32 v88, v138, v134, s65
    v_perm_b32 v89, v138, v134, s66
    v_dot2_f32_bf16 v72, v88, v81, v72
    v_dot2_f32_bf16 v73, v89, v81, v73
    v_perm_b32 v90, v139, v135, s65
    v_perm_b32 v91, v139, v135, s66
    v_dot2_f32_bf16 v74, v90, v81, v74
    v_dot2_f32_bf16 v75, v91, v81, v75
    v_perm_b32 v88, v144, v140, s65
    v_perm_b32 v89, v144, v140, s66
    v_dot2_f32_bf16 v68, v88, v82, v68
    v_dot2_f32_bf16 v69, v89, v82, v69
    v_perm_b32 v90, v145, v141, s65
    v_perm_b32 v91, v145, v141, s66
    v_dot2_f32_bf16 v70, v90, v82, v70
    v_dot2_f32_bf16 v71, v91, v82, v71
    v_perm_b32 v88, v146, v142, s65
    v_perm_b32 v89, v146, v142, s66
    v_dot2_f32_bf16 v72, v88, v82, v72
    v_dot2_f32_bf16 v73, v89, v82, v73
    v_perm_b32 v90, v147, v143, s65
    v_perm_b32 v91, v147, v143, s66
    v_dot2_f32_bf16 v74, v90, v82, v74
    v_dot2_f32_bf16 v75, v91, v82, v75
    v_perm_b32 v88, v152, v148, s65
    v_perm_b32 v89, v152, v148, s66
    v_dot2_f32_bf16 v68, v88, v83, v68
    v_dot2_f32_bf16 v69, v89, v83, v69
    v_perm_b32 v90, v153, v149, s65
    v_perm_b32 v91, v153, v149, s66
    v_dot2_f32_bf16 v70, v90, v83, v70
    v_dot2_f32_bf16 v71, v91, v83, v71
    v_perm_b32 v88, v154, v150, s65
    v_perm_b32 v89, v154, v150, s66
    v_dot2_f32_bf16 v72, v88, v83, v72
    v_dot2_f32_bf16 v73, v89, v83, v73
    v_perm_b32 v90, v155, v151, s65
    v_perm_b32 v91, v155, v151, s66
    v_dot2_f32_bf16 v74, v90, v83, v74
    v_dot2_f32_bf16 v75, v91, v83, v75
    s_nop 2
    s_setpc_b64 s[86:87]
.LcritA:
    v_and_b32 v255, 63, v0
    v_lshrrev_b32 v254, 6, v0
    v_lshlrev_b32 v254, 15, v254
    s_lshl_b32 s70, s59, 17
    v_lshl_add_u32 v254, v255, 4, v254
    s_add_u32 s61, s70, 0
    buffer_load_dwordx4 v[92:95], v254, s[76:79], s61 offen offset:0
    buffer_load_dwordx4 v[96:99], v254, s[76:79], s61 offen offset:1024
    buffer_load_dwordx4 v[100:103], v254, s[76:79], s61 offen offset:2048
    buffer_load_dwordx4 v[104:107], v254, s[76:79], s61 offen offset:3072
    s_add_u32 s61, s70, 4096
    buffer_load_dwordx4 v[108:111], v254, s[76:79], s61 offen offset:0
    buffer_load_dwordx4 v[112:115], v254, s[76:79], s61 offen offset:1024
    buffer_load_dwordx4 v[116:119], v254, s[76:79], s61 offen offset:2048
    buffer_load_dwordx4 v[120:123], v254, s[76:79], s61 offen offset:3072
    s_add_u32 s61, s70, 8192
    buffer_load_dwordx4 v[124:127], v254, s[76:79], s61 offen offset:0
    buffer_load_dwordx4 v[128:131], v254, s[76:79], s61 offen offset:1024
    buffer_load_dwordx4 v[132:135], v254, s[76:79], s61 offen offset:2048
    buffer_load_dwordx4 v[136:139], v254, s[76:79], s61 offen offset:3072
    s_add_u32 s61, s70, 12288
    buffer_load_dwordx4 v[140:143], v254, s[76:79], s61 offen offset:0
    buffer_load_dwordx4 v[144:147], v254, s[76:79], s61 offen offset:1024
    buffer_load_dwordx4 v[148:151], v254, s[76:79], s61 offen offset:2048
    buffer_load_dwordx4 v[152:155], v254, s[76:79], s61 offen offset:3072
    s_add_u32 s61, s70, 16384
    buffer_load_dwordx4 v[4:7], v254, s[76:79], s61 offen offset:0
    buffer_load_dwordx4 v[8:11], v254, s[76:79], s61 offen offset:1024
    buffer_load_dwordx4 v[12:15], v254, s[76:79], s61 offen offset:2048
    buffer_load_dwordx4 v[16:19], v254, s[76:79], s61 offen offset:3072
    s_add_u32 s61, s70, 20480
    buffer_load_dwordx4 v[20:23], v254, s[76:79], s61 offen offset:0
    buffer_load_dwordx4 v[24:27], v254, s[76:79], s61 offen offset:1024
    buffer_load_dwordx4 v[28:31], v254, s[76:79], s61 offen offset:2048
    buffer_load_dwordx4 v[32:35], v254, s[76:79], s61 offen offset:3072
    s_add_u32 s61, s70, 24576
    buffer_load_dwordx4 v[36:39], v254, s[76:79], s61 offen offset:0
    buffer_load_dwordx4 v[40:43], v254, s[76:79], s61 offen offset:1024
    buffer_load_dwordx4 v[44:47], v254, s[76:79], s61 offen offset:2048
    buffer_load_dwordx4 v[48:51], v254, s[76:79], s61 offen offset:3072
    s_add_u32 s61, s70, 28672
    buffer_load_dwordx4 v[52:55], v254, s[76:79], s61 offen offset:0
    buffer_load_dwordx4 v[56:59], v254, s[76:79], s61 offen offset:1024
    buffer_load_dwordx4 v[60:63], v254, s[76:79], s61 offen offset:2048
    buffer_load_dwordx4 v[64:67], v254, s[76:79], s61 offen offset:3072
    s_cmp_lg_u32 s88, 1
    s_cbranch_scc1 .L1
    s_cmp_lg_u32 s60, 0
    s_cbranch_scc1 .L1
    v_mov_b32 v90, 0
    s_lshl_b32 s62, s56, 2
    s_mov_b32 s71, 0
    s_nop 0
.L2:
    buffer_load_dword v91, v90, s[52:55], s62 offen sc1
    s_waitcnt vmcnt(0)
    v_cmp_gt_u32 vcc, 32, v91
    s_nop 1
    v_cndmask_b32 v88, 0, 1, vcc
    v_mov_b32 v89, 0
    v_or_b32 v91, v88, v89
    v_and_b32 v91, 1, v91
    v_cmp_ne_u32 vcc, 0, v91
    s_nop 0
    s_cmp_eq_u64 vcc, 0
    s_nop 2
    s_cbranch_scc1 .L3
    s_sleep 16
    s_add_u32 s71, s71, 1
    s_cmp_lt_u32 s71, 131072
    s_cbranch_scc1 .L2
.L3:
.L1:
    s_waitcnt lgkmcnt(0)
    s_barrier
    v_lshrrev_b32 v86, 7, v0
    v_and_b32 v87, 127, v0
    v_lshlrev_b32 v87, 2, v87
    v_lshlrev_b32 v84, 5, v86
    ds_read_b128 v[68:71], v84 offset:4096
    ds_read_b128 v[72:75], v84 offset:4112
    ds_read_b128 v[76:79], v84 offset:4608
    ds_read_b128 v[80:83], v84 offset:4624
    v_lshl_add_u32 v85, v86, 9, v87
    s_waitcnt lgkmcnt(0)
    v_max3_f32 v88, v68, v69, v70
    v_max3_f32 v88, v88, v71, v72
    v_max3_f32 v88, v88, v73, v74
    v_max_f32 v88, v88, v75
    v_sub_f32 v68, v68, v88
    v_sub_f32 v69, v69, v88
    v_sub_f32 v70, v70, v88
    v_sub_f32 v71, v71, v88
    v_sub_f32 v72, v72, v88
    v_sub_f32 v73, v73, v88
    v_sub_f32 v74, v74, v88
    v_sub_f32 v75, v75, v88
    v_mul_f32 v68, s68, v68
    v_mul_f32 v69, s68, v69
    v_mul_f32 v70, s68, v70
    v_mul_f32 v71, s68, v71
    v_mul_f32 v72, s68, v72
    v_mul_f32 v73, s68, v73
    v_mul_f32 v74, s68, v74
    v_mul_f32 v75, s68, v75
    v_exp_f32 v68, v68
    v_exp_f32 v69, v69
    v_exp_f32 v70, v70
    v_exp_f32 v71, v71
    v_exp_f32 v72, v72
    v_exp_f32 v73, v73
    v_exp_f32 v74, v74
    v_exp_f32 v75, v75
    v_mul_f32 v89, v68, v76
    v_fma_f32 v89, v69, v77, v89
    v_fma_f32 v89, v70, v78, v89
    v_fma_f32 v89, v71, v79, v89
    v_fma_f32 v89, v72, v80, v89
    v_fma_f32 v89, v73, v81, v89
    v_fma_f32 v89, v74, v82, v89
    v_fma_f32 v89, v75, v83, v89
    ds_read_b32 v76, v85 offset:8192
    ds_read_b32 v77, v85 offset:12288
    ds_read_b32 v78, v85 offset:16384
    ds_read_b32 v79, v85 offset:20480
    ds_read_b32 v80, v85 offset:24576
    ds_read_b32 v81, v85 offset:28672
    ds_read_b32 v82, v85 offset:32768
    ds_read_b32 v83, v85 offset:36864
    s_waitcnt lgkmcnt(0)
    v_mul_f32 v90, v68, v76
    v_fma_f32 v90, v69, v77, v90
    v_fma_f32 v90, v70, v78, v90
    v_fma_f32 v90, v71, v79, v90
    v_fma_f32 v90, v72, v80, v90
    v_fma_f32 v90, v73, v81, v90
    v_fma_f32 v90, v74, v82, v90
    v_fma_f32 v90, v75, v83, v90
    v_add_u32 v86, 2, v86
    v_lshlrev_b32 v84, 5, v86
    ds_read_b128 v[68:71], v84 offset:4096
    ds_read_b128 v[72:75], v84 offset:4112
    ds_read_b128 v[76:79], v84 offset:4608
    ds_read_b128 v[80:83], v84 offset:4624
    v_lshl_add_u32 v85, v86, 9, v87
    s_waitcnt lgkmcnt(0)
    v_max3_f32 v254, v68, v69, v70
    v_max3_f32 v254, v254, v71, v72
    v_max3_f32 v254, v254, v73, v74
    v_max_f32 v254, v254, v75
    v_sub_f32 v68, v68, v254
    v_sub_f32 v69, v69, v254
    v_sub_f32 v70, v70, v254
    v_sub_f32 v71, v71, v254
    v_sub_f32 v72, v72, v254
    v_sub_f32 v73, v73, v254
    v_sub_f32 v74, v74, v254
    v_sub_f32 v75, v75, v254
    v_mul_f32 v68, s68, v68
    v_mul_f32 v69, s68, v69
    v_mul_f32 v70, s68, v70
    v_mul_f32 v71, s68, v71
    v_mul_f32 v72, s68, v72
    v_mul_f32 v73, s68, v73
    v_mul_f32 v74, s68, v74
    v_mul_f32 v75, s68, v75
    v_exp_f32 v68, v68
    v_exp_f32 v69, v69
    v_exp_f32 v70, v70
    v_exp_f32 v71, v71
    v_exp_f32 v72, v72
    v_exp_f32 v73, v73
    v_exp_f32 v74, v74
    v_exp_f32 v75, v75
    v_mul_f32 v255, v68, v76
    v_fma_f32 v255, v69, v77, v255
    v_fma_f32 v255, v70, v78, v255
    v_fma_f32 v255, v71, v79, v255
    v_fma_f32 v255, v72, v80, v255
    v_fma_f32 v255, v73, v81, v255
    v_fma_f32 v255, v74, v82, v255
    v_fma_f32 v255, v75, v83, v255
    ds_read_b32 v76, v85 offset:8192
    ds_read_b32 v77, v85 offset:12288
    ds_read_b32 v78, v85 offset:16384
    ds_read_b32 v79, v85 offset:20480
    ds_read_b32 v80, v85 offset:24576
    ds_read_b32 v81, v85 offset:28672
    ds_read_b32 v82, v85 offset:32768
    ds_read_b32 v83, v85 offset:36864
    s_waitcnt lgkmcnt(0)
    v_mul_f32 v91, v68, v76
    v_fma_f32 v91, v69, v77, v91
    v_fma_f32 v91, v70, v78, v91
    v_fma_f32 v91, v71, v79, v91
    v_fma_f32 v91, v72, v80, v91
    v_fma_f32 v91, v73, v81, v91
    v_fma_f32 v91, v74, v82, v91
    v_fma_f32 v91, v75, v83, v91
    s_lshl_b32 s61, s95, 2
    s_add_u32 s61, s61, s58
    s_lshl_b32 s62, s61, 11
    s_add_u32 s62, s62, s90
    v_lshlrev_b32 v84, 2, v0
    v_and_b32 v88, -2, v88
    v_and_b32 v89, -2, v89
    v_and_b32 v90, -2, v90
    v_and_b32 v91, -2, v91
    v_and_b32 v254, -2, v254
    v_and_b32 v255, -2, v255
    s_add_u32 s70, s62, 4194304
    buffer_store_dword v90, v84, s[40:43], s70 offen
    buffer_store_dword v91, v84, s[40:43], s70 offen offset:1024
    buffer_store_dword v90, v84, s[40:43], s62 offen sc1
    buffer_store_dword v91, v84, s[40:43], s62 offen offset:1024 sc1
    s_lshl_b32 s61, s61, 5
    s_add_u32 s61, s61, s91
    v_lshlrev_b32 v85, 3, v86
    v_cmp_eq_u32 vcc, 0, v87
    s_nop 0
    s_and_saveexec_b64 s[72:73], vcc
    s_nop 2
    s_cbranch_execz .L4
    v_add_u32 v84, -16, v85
    s_add_u32 s70, s61, 4194304
    buffer_store_dwordx2 v[88:89], v84, s[40:43], s70 offen
    buffer_store_dwordx2 v[254:255], v85, s[40:43], s70 offen
    buffer_store_dwordx2 v[88:89], v84, s[40:43], s61 offen sc1
    buffer_store_dwordx2 v[254:255], v85, s[40:43], s61 offen sc1
.L4:
    s_mov_b64 exec, s[72:73]
    s_lshl_b32 s61, s95, 4
    s_add_u32 s61, s61, s58
    s_lshl_b32 s70, s61, 9
    s_add_u32 s70, s70, s90
    s_lshl_b32 s61, s61, 3
    s_add_u32 s61, s61, s91
    v_and_b32 v80, 127, v0
    v_lshlrev_b32 v81, 2, v80
    v_mov_b32 v82, 0
    s_mov_b32 s71, 0
    s_nop 1
.L5:
    s_and_b32 s62, s71, 3
    s_cmp_eq_u32 s62, 3
    s_cselect_b32 s62, 0, 4194304
    s_add_u32 s62, s62, s70
    s_and_b32 s72, s71, 3
    s_cmp_eq_u32 s72, 3
    s_cselect_b32 s72, 0, 4194304
    s_add_u32 s72, s72, s61
    buffer_load_dword v68, v81, s[40:43], s62 offen sc1
    s_add_u32 s62, s62, 2048
    buffer_load_dwordx2 v[72:73], v82, s[40:43], s72 offen offset:0 sc1
    buffer_load_dword v69, v81, s[40:43], s62 offen sc1
    s_add_u32 s62, s62, 2048
    buffer_load_dwordx2 v[74:75], v82, s[40:43], s72 offen offset:32 sc1
    buffer_load_dword v70, v81, s[40:43], s62 offen sc1
    s_add_u32 s62, s62, 2048
    buffer_load_dwordx2 v[76:77], v82, s[40:43], s72 offen offset:64 sc1
    buffer_load_dword v71, v81, s[40:43], s62 offen sc1
    s_add_u32 s62, s62, 2048
    buffer_load_dwordx2 v[78:79], v82, s[40:43], s72 offen offset:96 sc1
    s_waitcnt vmcnt(0)
    v_or3_b32 v83, v68, v69, v70
    v_or3_b32 v83, v83, v71, v72
    v_or3_b32 v83, v83, v73, v74
    v_or3_b32 v83, v83, v75, v76
    v_or3_b32 v83, v83, v77, v78
    v_or_b32 v83, v83, v79
    v_and_b32 v83, 1, v83
    v_cmp_ne_u32 vcc, 0, v83
    s_nop 0
    s_cmp_eq_u64 vcc, 0
    s_nop 2
    s_cbranch_scc1 .L6
    s_sleep 1
    s_add_u32 s71, s71, 1
    s_cmp_lt_u32 s71, 131072
    s_cbranch_scc1 .L5
.L6:
    v_max3_f32 v83, v72, v74, v76
    v_max_f32 v83, v83, v78
    v_sub_f32 v72, v72, v83
    v_sub_f32 v74, v74, v83
    v_sub_f32 v76, v76, v83
    v_sub_f32 v78, v78, v83
    v_mul_f32 v72, s68, v72
    v_mul_f32 v74, s68, v74
    v_mul_f32 v76, s68, v76
    v_mul_f32 v78, s68, v78
    v_exp_f32 v72, v72
    v_exp_f32 v74, v74
    v_exp_f32 v76, v76
    v_exp_f32 v78, v78
    v_mul_f32 v84, v72, v73
    v_mul_f32 v85, v72, v68
    v_fma_f32 v84, v74, v75, v84
    v_fma_f32 v85, v74, v69, v85
    v_fma_f32 v84, v76, v77, v84
    v_fma_f32 v85, v76, v70, v85
    v_fma_f32 v84, v78, v79, v84
    v_fma_f32 v85, v78, v71, v85
    v_rcp_f32 v84, v84
    s_nop 0
    v_mul_f32 v85, v85, v84
    v_cvt_pk_bf16_f32 v85, v85, v85
    v_lshlrev_b32 v80, 1, v80
    ds_write_b16 v80, v85 offset:3072
    s_waitcnt lgkmcnt(0)
    v_mov_b32 v90, 0
    v_mov_b32 v91, 1
    s_mov_b64 exec, 1
    ds_add_u32 v90, v91 offset:512
    s_mov_b64 exec, -1
    s_add_u32 s96, s96, 4
.L7:
    ds_read_b32 v91, v90 offset:512
    s_waitcnt lgkmcnt(0)
    v_readfirstlane_b32 s71, v91
    s_nop 0
    s_cmp_lt_u32 s71, s96
    s_nop 2
    s_cbranch_scc1 .L7
    s_branch .Loutproj
.LcritB:
    v_and_b32 v255, 63, v0
    v_lshrrev_b32 v254, 6, v0
    v_lshlrev_b32 v254, 15, v254
    s_lshl_b32 s70, s59, 17
    v_lshl_add_u32 v254, v255, 4, v254
    s_add_u32 s61, s70, 0
    buffer_load_dwordx4 v[92:95], v254, s[76:79], s61 offen offset:0
    buffer_load_dwordx4 v[96:99], v254, s[76:79], s61 offen offset:1024
    buffer_load_dwordx4 v[100:103], v254, s[76:79], s61 offen offset:2048
    buffer_load_dwordx4 v[104:107], v254, s[76:79], s61 offen offset:3072
    s_add_u32 s61, s70, 4096
    buffer_load_dwordx4 v[108:111], v254, s[76:79], s61 offen offset:0
    buffer_load_dwordx4 v[112:115], v254, s[76:79], s61 offen offset:1024
    buffer_load_dwordx4 v[116:119], v254, s[76:79], s61 offen offset:2048
    buffer_load_dwordx4 v[120:123], v254, s[76:79], s61 offen offset:3072
    s_add_u32 s61, s70, 8192
    buffer_load_dwordx4 v[124:127], v254, s[76:79], s61 offen offset:0
    buffer_load_dwordx4 v[128:131], v254, s[76:79], s61 offen offset:1024
    buffer_load_dwordx4 v[132:135], v254, s[76:79], s61 offen offset:2048
    buffer_load_dwordx4 v[136:139], v254, s[76:79], s61 offen offset:3072
    s_add_u32 s61, s70, 12288
    buffer_load_dwordx4 v[140:143], v254, s[76:79], s61 offen offset:0
    buffer_load_dwordx4 v[144:147], v254, s[76:79], s61 offen offset:1024
    buffer_load_dwordx4 v[148:151], v254, s[76:79], s61 offen offset:2048
    buffer_load_dwordx4 v[152:155], v254, s[76:79], s61 offen offset:3072
    s_add_u32 s61, s70, 16384
    buffer_load_dwordx4 v[4:7], v254, s[76:79], s61 offen offset:0
    buffer_load_dwordx4 v[8:11], v254, s[76:79], s61 offen offset:1024
    buffer_load_dwordx4 v[12:15], v254, s[76:79], s61 offen offset:2048
    buffer_load_dwordx4 v[16:19], v254, s[76:79], s61 offen offset:3072
    s_add_u32 s61, s70, 20480
    buffer_load_dwordx4 v[20:23], v254, s[76:79], s61 offen offset:0
    buffer_load_dwordx4 v[24:27], v254, s[76:79], s61 offen offset:1024
    buffer_load_dwordx4 v[28:31], v254, s[76:79], s61 offen offset:2048
    buffer_load_dwordx4 v[32:35], v254, s[76:79], s61 offen offset:3072
    s_add_u32 s61, s70, 24576
    buffer_load_dwordx4 v[36:39], v254, s[76:79], s61 offen offset:0
    buffer_load_dwordx4 v[40:43], v254, s[76:79], s61 offen offset:1024
    buffer_load_dwordx4 v[44:47], v254, s[76:79], s61 offen offset:2048
    buffer_load_dwordx4 v[48:51], v254, s[76:79], s61 offen offset:3072
    s_add_u32 s61, s70, 28672
    buffer_load_dwordx4 v[52:55], v254, s[76:79], s61 offen offset:0
    buffer_load_dwordx4 v[56:59], v254, s[76:79], s61 offen offset:1024
    buffer_load_dwordx4 v[60:63], v254, s[76:79], s61 offen offset:2048
    buffer_load_dwordx4 v[64:67], v254, s[76:79], s61 offen offset:3072
    s_waitcnt lgkmcnt(0)
    s_barrier
    v_mov_b32 v86, 0
    v_and_b32 v87, 127, v0
    v_lshlrev_b32 v87, 2, v87
    v_lshlrev_b32 v84, 5, v86
    ds_read_b128 v[68:71], v84 offset:4096
    ds_read_b128 v[72:75], v84 offset:4112
    ds_read_b128 v[76:79], v84 offset:4608
    ds_read_b128 v[80:83], v84 offset:4624
    v_lshl_add_u32 v85, v86, 9, v87
    s_waitcnt lgkmcnt(0)
    v_max3_f32 v88, v68, v69, v70
    v_max3_f32 v88, v88, v71, v72
    v_max3_f32 v88, v88, v73, v74
    v_max_f32 v88, v88, v75
    v_sub_f32 v68, v68, v88
    v_sub_f32 v69, v69, v88
    v_sub_f32 v70, v70, v88
    v_sub_f32 v71, v71, v88
    v_sub_f32 v72, v72, v88
    v_sub_f32 v73, v73, v88
    v_sub_f32 v74, v74, v88
    v_sub_f32 v75, v75, v88
    v_mul_f32 v68, s68, v68
    v_mul_f32 v69, s68, v69
    v_mul_f32 v70, s68, v70
    v_mul_f32 v71, s68, v71
    v_mul_f32 v72, s68, v72
    v_mul_f32 v73, s68, v73
    v_mul_f32 v74, s68, v74
    v_mul_f32 v75, s68, v75
    v_exp_f32 v68, v68
    v_exp_f32 v69, v69
    v_exp_f32 v70, v70
    v_exp_f32 v71, v71
    v_exp_f32 v72, v72
    v_exp_f32 v73, v73
    v_exp_f32 v74, v74
    v_exp_f32 v75, v75
    v_mul_f32 v89, v68, v76
    v_fma_f32 v89, v69, v77, v89
    v_fma_f32 v89, v70, v78, v89
    v_fma_f32 v89, v71, v79, v89
    v_fma_f32 v89, v72, v80, v89
    v_fma_f32 v89, v73, v81, v89
    v_fma_f32 v89, v74, v82, v89
    v_fma_f32 v89, v75, v83, v89
    ds_read_b32 v76, v85 offset:8192
    ds_read_b32 v77, v85 offset:12288
    ds_read_b32 v78, v85 offset:16384
    ds_read_b32 v79, v85 offset:20480
    ds_read_b32 v80, v85 offset:24576
    ds_read_b32 v81, v85 offset:28672
    ds_read_b32 v82, v85 offset:32768
    ds_read_b32 v83, v85 offset:36864
    s_waitcnt lgkmcnt(0)
    v_mul_f32 v90, v68, v76
    v_fma_f32 v90, v69, v77, v90
    v_fma_f32 v90, v70, v78, v90
    v_fma_f32 v90, v71, v79, v90
    v_fma_f32 v90, v72, v80, v90
    v_fma_f32 v90, v73, v81, v90
    v_fma_f32 v90, v74, v82, v90
    v_fma_f32 v90, v75, v83, v90
    v_rcp_f32 v89, v89
    s_nop 0
    v_mul_f32 v90, v90, v89
    v_cvt_pk_bf16_f32 v90, v90, v90
    v_lshrrev_b32 v87, 1, v87
    ds_write_b16 v87, v90 offset:3072
    s_waitcnt lgkmcnt(0)
    v_mov_b32 v90, 0
    v_mov_b32 v91, 1
    s_mov_b64 exec, 1
    ds_add_u32 v90, v91 offset:512
    s_mov_b64 exec, -1
    s_add_u32 s96, s96, 4
.L8:
    ds_read_b32 v91, v90 offset:512
    s_waitcnt lgkmcnt(0)
    v_readfirstlane_b32 s71, v91
    s_nop 0
    s_cmp_lt_u32 s71, s96
    s_nop 2
    s_cbranch_scc1 .L8
.Loutproj:
    v_lshrrev_b32 v87, 6, v0
    v_lshlrev_b32 v87, 6, v87
    v_mov_b32 v68, 0
    v_mov_b32 v69, 0
    v_mov_b32 v70, 0
    v_mov_b32 v71, 0
    v_mov_b32 v72, 0
    v_mov_b32 v73, 0
    v_mov_b32 v74, 0
    v_mov_b32 v75, 0
    ds_read_b128 v[76:79], v87 offset:3072
    ds_read_b128 v[80:83], v87 offset:3088
    s_waitcnt vmcnt(16) lgkmcnt(0)
    s_call_b64 s[86:87], .Lgemv_92
    ds_read_b128 v[76:79], v87 offset:3104
    ds_read_b128 v[80:83], v87 offset:3120
    s_waitcnt vmcnt(0) lgkmcnt(0)
    s_call_b64 s[86:87], .Lgemv_4
    v_lshlrev_b32 v84, 5, v0
    ds_write_b128 v84, v[68:71] offset:8192
    ds_write_b128 v84, v[72:75] offset:8208
    v_and_b32 v86, 255, v0
    v_lshlrev_b32 v86, 2, v86
    s_waitcnt lgkmcnt(0)
    v_mov_b32 v90, 0
    v_mov_b32 v91, 1
    s_mov_b64 exec, 1
    ds_add_u32 v90, v91 offset:512
    s_mov_b64 exec, -1
    s_add_u32 s96, s96, 4
.L9:
    ds_read_b32 v91, v90 offset:512
    s_waitcnt lgkmcnt(0)
    v_readfirstlane_b32 s71, v91
    s_nop 0
    s_cmp_lt_u32 s71, s96
    s_nop 2
    s_cbranch_scc1 .L9
    ds_read_b32 v68, v86 offset:8192
    ds_read_b32 v72, v86 offset:9216
    ds_read_b32 v69, v86 offset:10240
    ds_read_b32 v73, v86 offset:11264
    ds_read_b32 v70, v86 offset:12288
    ds_read_b32 v74, v86 offset:13312
    ds_read_b32 v71, v86 offset:14336
    ds_read_b32 v75, v86 offset:15360
    s_waitcnt lgkmcnt(0)
    v_add_f32 v68, v68, v69
    v_add_f32 v70, v70, v71
    v_add_f32 v84, v68, v70
    v_add_f32 v72, v72, v73
    v_add_f32 v74, v74, v75
    v_add_f32 v85, v72, v74
    s_lshl_b32 s61, s94, 11
    s_add_u32 s61, s61, s89
    v_lshlrev_b32 v86, 2, v0
    v_and_b32 v84, -2, v84
    v_and_b32 v85, -2, v85
    buffer_store_dword v84, v86, s[40:43], s61 offen sc1
    buffer_store_dword v85, v86, s[40:43], s61 offen offset:1024 sc1
    s_cmp_lg_u32 s88, 4
    s_cbranch_scc1 .L10
    s_and_b32 s61, s2, 31
    s_cmp_lg_u32 s61, 0
    s_cbranch_scc1 .Lend
.L10:
    v_and_b32 v255, 15, v0
    v_lshrrev_b32 v254, 4, v0
    v_lshlrev_b32 v254, 18, v254
    s_lshl_b32 s70, s59, 8
    v_lshl_add_u32 v254, v255, 4, v254
    s_add_u32 s61, s70, 0
    buffer_load_dwordx4 v[92:95], v254, s[80:83], s61 offen offset:0
    s_add_u32 s61, s70, 8192
    buffer_load_dwordx4 v[96:99], v254, s[80:83], s61 offen offset:0
    s_add_u32 s61, s70, 16384
    buffer_load_dwordx4 v[100:103], v254, s[80:83], s61 offen offset:0
    s_add_u32 s61, s70, 24576
    buffer_load_dwordx4 v[104:107], v254, s[80:83], s61 offen offset:0
    s_add_u32 s61, s70, 32768
    buffer_load_dwordx4 v[108:111], v254, s[80:83], s61 offen offset:0
    s_add_u32 s61, s70, 40960
    buffer_load_dwordx4 v[112:115], v254, s[80:83], s61 offen offset:0
    s_add_u32 s61, s70, 49152
    buffer_load_dwordx4 v[116:119], v254, s[80:83], s61 offen offset:0
    s_add_u32 s61, s70, 57344
    buffer_load_dwordx4 v[120:123], v254, s[80:83], s61 offen offset:0
    s_add_u32 s61, s70, 65536
    buffer_load_dwordx4 v[124:127], v254, s[80:83], s61 offen offset:0
    s_add_u32 s61, s70, 73728
    buffer_load_dwordx4 v[128:131], v254, s[80:83], s61 offen offset:0
    s_add_u32 s61, s70, 81920
    buffer_load_dwordx4 v[132:135], v254, s[80:83], s61 offen offset:0
    s_add_u32 s61, s70, 90112
    buffer_load_dwordx4 v[136:139], v254, s[80:83], s61 offen offset:0
    s_add_u32 s61, s70, 98304
    buffer_load_dwordx4 v[140:143], v254, s[80:83], s61 offen offset:0
    s_add_u32 s61, s70, 106496
    buffer_load_dwordx4 v[144:147], v254, s[80:83], s61 offen offset:0
    s_add_u32 s61, s70, 114688
    buffer_load_dwordx4 v[148:151], v254, s[80:83], s61 offen offset:0
    s_add_u32 s61, s70, 122880
    buffer_load_dwordx4 v[152:155], v254, s[80:83], s61 offen offset:0
    s_lshl_b32 s61, s56, 16
    s_add_u32 s61, s61, s89
    v_and_b32 v90, 31, v0
    v_lshlrev_b32 v90, 11, v90
    v_and_b32 v91, 0xe0, v0
    v_lshl_add_u32 v90, v91, 3, v90
    v_lshlrev_b32 v255, 3, v0
    v_mov_b32 v87, v90
    s_mov_b32 s64, 0
    s_nop 1
    s_branch .L11
.L12:
    s_mov_b32 s71, 0
.L14:
    buffer_load_dwordx2 v[88:89], v87, s[40:43], s61 offen sc1
    s_waitcnt vmcnt(0)
    v_or_b32 v91, v88, v89
    v_and_b32 v91, 1, v91
    v_cmp_ne_u32 vcc, 0, v91
    s_nop 0
    s_cmp_eq_u64 vcc, 0
    s_nop 2
    s_cbranch_scc1 .L15
    s_sleep 1
    s_add_u32 s71, s71, 1
    s_cmp_lt_u32 s71, 131072
    s_cbranch_scc1 .L14
.L15:
.L11:
    s_mov_b32 s62, s61
    buffer_load_dwordx2 v[4:5], v255, s[40:43], s62 offen offset:0 sc1
    buffer_load_dwordx2 v[6:7], v255, s[40:43], s62 offen offset:2048 sc1
    s_add_u32 s62, s62, 4096
    buffer_load_dwordx2 v[8:9], v255, s[40:43], s62 offen offset:0 sc1
    buffer_load_dwordx2 v[10:11], v255, s[40:43], s62 offen offset:2048 sc1
    s_add_u32 s62, s62, 4096
    buffer_load_dwordx2 v[12:13], v255, s[40:43], s62 offen offset:0 sc1
    buffer_load_dwordx2 v[14:15], v255, s[40:43], s62 offen offset:2048 sc1
    s_add_u32 s62, s62, 4096
    buffer_load_dwordx2 v[16:17], v255, s[40:43], s62 offen offset:0 sc1
    buffer_load_dwordx2 v[18:19], v255, s[40:43], s62 offen offset:2048 sc1
    s_add_u32 s62, s62, 4096
    buffer_load_dwordx2 v[20:21], v255, s[40:43], s62 offen offset:0 sc1
    buffer_load_dwordx2 v[22:23], v255, s[40:43], s62 offen offset:2048 sc1
    s_add_u32 s62, s62, 4096
    buffer_load_dwordx2 v[24:25], v255, s[40:43], s62 offen offset:0 sc1
    buffer_load_dwordx2 v[26:27], v255, s[40:43], s62 offen offset:2048 sc1
    s_add_u32 s62, s62, 4096
    buffer_load_dwordx2 v[28:29], v255, s[40:43], s62 offen offset:0 sc1
    buffer_load_dwordx2 v[30:31], v255, s[40:43], s62 offen offset:2048 sc1
    s_add_u32 s62, s62, 4096
    buffer_load_dwordx2 v[32:33], v255, s[40:43], s62 offen offset:0 sc1
    buffer_load_dwordx2 v[34:35], v255, s[40:43], s62 offen offset:2048 sc1
    s_add_u32 s62, s62, 4096
    buffer_load_dwordx2 v[36:37], v255, s[40:43], s62 offen offset:0 sc1
    buffer_load_dwordx2 v[38:39], v255, s[40:43], s62 offen offset:2048 sc1
    s_add_u32 s62, s62, 4096
    buffer_load_dwordx2 v[40:41], v255, s[40:43], s62 offen offset:0 sc1
    buffer_load_dwordx2 v[42:43], v255, s[40:43], s62 offen offset:2048 sc1
    s_add_u32 s62, s62, 4096
    buffer_load_dwordx2 v[44:45], v255, s[40:43], s62 offen offset:0 sc1
    buffer_load_dwordx2 v[46:47], v255, s[40:43], s62 offen offset:2048 sc1
    s_add_u32 s62, s62, 4096
    buffer_load_dwordx2 v[48:49], v255, s[40:43], s62 offen offset:0 sc1
    buffer_load_dwordx2 v[50:51], v255, s[40:43], s62 offen offset:2048 sc1
    s_add_u32 s62, s62, 4096
    buffer_load_dwordx2 v[52:53], v255, s[40:43], s62 offen offset:0 sc1
    buffer_load_dwordx2 v[54:55], v255, s[40:43], s62 offen offset:2048 sc1
    s_add_u32 s62, s62, 4096
    buffer_load_dwordx2 v[56:57], v255, s[40:43], s62 offen offset:0 sc1
    buffer_load_dwordx2 v[58:59], v255, s[40:43], s62 offen offset:2048 sc1
    s_add_u32 s62, s62, 4096
    buffer_load_dwordx2 v[60:61], v255, s[40:43], s62 offen offset:0 sc1
    buffer_load_dwordx2 v[62:63], v255, s[40:43], s62 offen offset:2048 sc1
    s_add_u32 s62, s62, 4096
    buffer_load_dwordx2 v[64:65], v255, s[40:43], s62 offen offset:0 sc1
    buffer_load_dwordx2 v[66:67], v255, s[40:43], s62 offen offset:2048 sc1
    s_waitcnt vmcnt(0)
    v_or3_b32 v91, v4, v5, v6
    v_or3_b32 v91, v91, v7, v8
    v_or3_b32 v91, v91, v9, v10
    v_or3_b32 v91, v91, v11, v12
    v_or3_b32 v91, v91, v13, v14
    v_or3_b32 v91, v91, v15, v16
    v_or3_b32 v91, v91, v17, v18
    v_or3_b32 v91, v91, v19, v20
    v_or3_b32 v91, v91, v21, v22
    v_or3_b32 v91, v91, v23, v24
    v_or3_b32 v91, v91, v25, v26
    v_or3_b32 v91, v91, v27, v28
    v_or3_b32 v91, v91, v29, v30
    v_or3_b32 v91, v91, v31, v32
    v_or3_b32 v91, v91, v33, v34
    v_or3_b32 v91, v91, v35, v36
    v_or3_b32 v91, v91, v37, v38
    v_or3_b32 v91, v91, v39, v40
    v_or3_b32 v91, v91, v41, v42
    v_or3_b32 v91, v91, v43, v44
    v_or3_b32 v91, v91, v45, v46
    v_or3_b32 v91, v91, v47, v48
    v_or3_b32 v91, v91, v49, v50
    v_or3_b32 v91, v91, v51, v52
    v_or3_b32 v91, v91, v53, v54
    v_or3_b32 v91, v91, v55, v56
    v_or3_b32 v91, v91, v57, v58
    v_or3_b32 v91, v91, v59, v60
    v_or3_b32 v91, v91, v61, v62
    v_or3_b32 v91, v91, v63, v64
    v_or3_b32 v91, v91, v65, v66
    v_or_b32 v91, v91, v67
    v_and_b32 v91, 1, v91
    v_cmp_ne_u32 vcc, 0, v91
    s_nop 0
    s_cmp_eq_u64 vcc, 0
    s_nop 2
    s_cbranch_scc1 .L13
    s_add_u32 s64, s64, 1
    s_cmp_lt_u32 s64, 64
    s_cbranch_scc1 .L12
.L13:
    v_add_f32 v4, v4, v36
    v_add_f32 v5, v5, v37
    v_add_f32 v6, v6, v38
    v_add_f32 v7, v7, v39
    v_add_f32 v8, v8, v40
    v_add_f32 v9, v9, v41
    v_add_f32 v10, v10, v42
    v_add_f32 v11, v11, v43
    v_add_f32 v12, v12, v44
    v_add_f32 v13, v13, v45
    v_add_f32 v14, v14, v46
    v_add_f32 v15, v15, v47
    v_add_f32 v16, v16, v48
    v_add_f32 v17, v17, v49
    v_add_f32 v18, v18, v50
    v_add_f32 v19, v19, v51
    v_add_f32 v20, v20, v52
    v_add_f32 v21, v21, v53
    v_add_f32 v22, v22, v54
    v_add_f32 v23, v23, v55
    v_add_f32 v24, v24, v56
    v_add_f32 v25, v25, v57
    v_add_f32 v26, v26, v58
    v_add_f32 v27, v27, v59
    v_add_f32 v28, v28, v60
    v_add_f32 v29, v29, v61
    v_add_f32 v30, v30, v62
    v_add_f32 v31, v31, v63
    v_add_f32 v32, v32, v64
    v_add_f32 v33, v33, v65
    v_add_f32 v34, v34, v66
    v_add_f32 v35, v35, v67
    v_add_f32 v4, v4, v20
    v_add_f32 v5, v5, v21
    v_add_f32 v6, v6, v22
    v_add_f32 v7, v7, v23
    v_add_f32 v8, v8, v24
    v_add_f32 v9, v9, v25
    v_add_f32 v10, v10, v26
    v_add_f32 v11, v11, v27
    v_add_f32 v12, v12, v28
    v_add_f32 v13, v13, v29
    v_add_f32 v14, v14, v30
    v_add_f32 v15, v15, v31
    v_add_f32 v16, v16, v32
    v_add_f32 v17, v17, v33
    v_add_f32 v18, v18, v34
    v_add_f32 v19, v19, v35
    v_add_f32 v4, v4, v12
    v_add_f32 v5, v5, v13
    v_add_f32 v6, v6, v14
    v_add_f32 v7, v7, v15
    v_add_f32 v8, v8, v16
    v_add_f32 v9, v9, v17
    v_add_f32 v10, v10, v18
    v_add_f32 v11, v11, v19
    v_add_f32 v4, v4, v8
    v_add_f32 v5, v5, v9
    v_add_f32 v6, v6, v10
    v_add_f32 v7, v7, v11
    v_add_f32 v4, v4, v6
    v_add_f32 v5, v5, v7
    v_cvt_pk_bf16_f32 v84, v4, v5
    v_lshlrev_b32 v85, 16, v84
    v_and_b32 v86, s69, v84
    v_add_f32 v252, v252, v85
    v_add_f32 v253, v253, v86
    v_cvt_pk_bf16_f32 v84, v252, v253
    v_lshlrev_b32 v252, 16, v84
    v_and_b32 v253, s69, v84
    s_cmp_lg_u32 s88, 4
    s_nop 1
    s_cbranch_scc1 .L16
    s_lshl_b32 s61, s56, 10
    v_lshlrev_b32 v255, 2, v0
    buffer_store_dword v84, v255, s[48:51], s61 offen
    s_nop 1
    s_branch .Lend
.L16:
    s_add_u32 s61, s70, 131072
    buffer_load_dwordx4 v[4:7], v254, s[80:83], s61 offen offset:0
    s_add_u32 s61, s70, 139264
    buffer_load_dwordx4 v[8:11], v254, s[80:83], s61 offen offset:0
    s_add_u32 s61, s70, 147456
    buffer_load_dwordx4 v[12:15], v254, s[80:83], s61 offen offset:0
    s_add_u32 s61, s70, 155648
    buffer_load_dwordx4 v[16:19], v254, s[80:83], s61 offen offset:0
    s_add_u32 s61, s70, 163840
    buffer_load_dwordx4 v[20:23], v254, s[80:83], s61 offen offset:0
    s_add_u32 s61, s70, 172032
    buffer_load_dwordx4 v[24:27], v254, s[80:83], s61 offen offset:0
    s_add_u32 s61, s70, 180224
    buffer_load_dwordx4 v[28:31], v254, s[80:83], s61 offen offset:0
    s_add_u32 s61, s70, 188416
    buffer_load_dwordx4 v[32:35], v254, s[80:83], s61 offen offset:0
    s_add_u32 s61, s70, 196608
    buffer_load_dwordx4 v[36:39], v254, s[80:83], s61 offen offset:0
    s_add_u32 s61, s70, 204800
    buffer_load_dwordx4 v[40:43], v254, s[80:83], s61 offen offset:0
    s_add_u32 s61, s70, 212992
    buffer_load_dwordx4 v[44:47], v254, s[80:83], s61 offen offset:0
    s_add_u32 s61, s70, 221184
    buffer_load_dwordx4 v[48:51], v254, s[80:83], s61 offen offset:0
    s_add_u32 s61, s70, 229376
    buffer_load_dwordx4 v[52:55], v254, s[80:83], s61 offen offset:0
    s_add_u32 s61, s70, 237568
    buffer_load_dwordx4 v[56:59], v254, s[80:83], s61 offen offset:0
    s_add_u32 s61, s70, 245760
    buffer_load_dwordx4 v[60:63], v254, s[80:83], s61 offen offset:0
    s_add_u32 s61, s70, 253952
    buffer_load_dwordx4 v[64:67], v254, s[80:83], s61 offen offset:0
.Lqpart:
    v_add_f32 v86, v252, v253
    s_nop 1
    v_add_f32_dpp v86, v86, v86 row_ror:8 row_mask:0xf bank_mask:0xf
    s_nop 1
    v_add_f32_dpp v86, v86, v86 row_ror:4 row_mask:0xf bank_mask:0xf
    s_nop 1
    v_add_f32_dpp v86, v86, v86 row_ror:2 row_mask:0xf bank_mask:0xf
    s_nop 1
    v_add_f32_dpp v86, v86, v86 row_ror:1 row_mask:0xf bank_mask:0xf
    v_lshrrev_b32 v84, 4, v0
    v_lshlrev_b32 v84, 2, v84
    ds_write_b32 v84, v86 offset:0
    v_mov_b32 v85, 0
    s_waitcnt lgkmcnt(0)
    v_mov_b32 v90, 0
    v_mov_b32 v91, 1
    s_mov_b64 exec, 1
    ds_add_u32 v90, v91 offset:512
    s_mov_b64 exec, -1
    s_add_u32 s96, s96, 4
.L17:
    ds_read_b32 v91, v90 offset:512
    s_waitcnt lgkmcnt(0)
    v_readfirstlane_b32 s71, v91
    s_nop 0
    s_cmp_lt_u32 s71, s96
    s_nop 2
    s_cbranch_scc1 .L17
    ds_read_b128 v[68:71], v85 offset:0
    ds_read_b128 v[72:75], v85 offset:16
    ds_read_b128 v[76:79], v85 offset:32
    ds_read_b128 v[80:83], v85 offset:48
    s_waitcnt lgkmcnt(0)
    v_add_f32 v68, v68, v76
    v_add_f32 v69, v69, v77
    v_add_f32 v70, v70, v78
    v_add_f32 v71, v71, v79
    v_add_f32 v72, v72, v80
    v_add_f32 v73, v73, v81
    v_add_f32 v74, v74, v82
    v_add_f32 v75, v75, v83
    v_add_f32 v68, v68, v72
    v_add_f32 v69, v69, v73
    v_add_f32 v70, v70, v74
    v_add_f32 v71, v71, v75
    v_add_f32 v68, v68, v70
    v_add_f32 v69, v69, v71
    v_add_f32 v68, v68, v69
    v_mov_b32 v86, v68
    v_mul_f32 v86, 0x3b000000, v86
    v_sub_f32 v88, v252, v86
    v_sub_f32 v89, v253, v86
    v_mul_f32 v87, v88, v88
    v_fma_f32 v87, v89, v89, v87
    s_nop 1
    v_add_f32_dpp v87, v87, v87 row_ror:8 row_mask:0xf bank_mask:0xf
    s_nop 1
    v_add_f32_dpp v87, v87, v87 row_ror:4 row_mask:0xf bank_mask:0xf
    s_nop 1
    v_add_f32_dpp v87, v87, v87 row_ror:2 row_mask:0xf bank_mask:0xf
    s_nop 1
    v_add_f32_dpp v87, v87, v87 row_ror:1 row_mask:0xf bank_mask:0xf
    v_lshrrev_b32 v84, 4, v0
    v_lshlrev_b32 v84, 2, v84
    ds_write_b32 v84, v87 offset:256
    v_mov_b32 v85, 0
    s_waitcnt lgkmcnt(0)
    v_mov_b32 v90, 0
    v_mov_b32 v91, 1
    s_mov_b64 exec, 1
    ds_add_u32 v90, v91 offset:512
    s_mov_b64 exec, -1
    s_add_u32 s96, s96, 4
.L18:
    ds_read_b32 v91, v90 offset:512
    s_waitcnt lgkmcnt(0)
    v_readfirstlane_b32 s71, v91
    s_nop 0
    s_cmp_lt_u32 s71, s96
    s_nop 2
    s_cbranch_scc1 .L18
    ds_read_b128 v[68:71], v85 offset:256
    ds_read_b128 v[72:75], v85 offset:272
    ds_read_b128 v[76:79], v85 offset:288
    ds_read_b128 v[80:83], v85 offset:304
    s_waitcnt lgkmcnt(0)
    v_add_f32 v68, v68, v76
    v_add_f32 v69, v69, v77
    v_add_f32 v70, v70, v78
    v_add_f32 v71, v71, v79
    v_add_f32 v72, v72, v80
    v_add_f32 v73, v73, v81
    v_add_f32 v74, v74, v82
    v_add_f32 v75, v75, v83
    v_add_f32 v68, v68, v72
    v_add_f32 v69, v69, v73
    v_add_f32 v70, v70, v74
    v_add_f32 v71, v71, v75
    v_add_f32 v68, v68, v70
    v_add_f32 v69, v69, v71
    v_add_f32 v68, v68, v69
    v_mov_b32 v87, v68
    v_mul_f32 v87, 0x3b000000, v87
    v_cvt_pk_bf16_f32 v68, v86, v86
    v_lshlrev_b32 v86, 16, v68
    v_cvt_pk_bf16_f32 v68, v87, v87
    v_lshlrev_b32 v87, 16, v68
    v_add_f32 v87, 0x3727c5ac, v87
    v_cvt_pk_bf16_f32 v68, v87, v87
    v_lshlrev_b32 v87, 16, v68
    v_sqrt_f32 v87, v87
    s_nop 0
    v_cvt_pk_bf16_f32 v68, v87, v87
    v_lshlrev_b32 v87, 16, v68
    v_rcp_f32 v87, v87
    v_sub_f32 v88, v252, v86
    v_sub_f32 v89, v253, v86
    v_cvt_pk_bf16_f32 v68, v88, v88
    v_lshlrev_b32 v88, 16, v68
    v_cvt_pk_bf16_f32 v68, v89, v89
    v_lshlrev_b32 v89, 16, v68
    v_mul_f32 v88, v88, v87
    v_mul_f32 v89, v89, v87
    v_cvt_pk_bf16_f32 v88, v88, v89
    v_lshlrev_b32 v68, 2, v0
    ds_write_b32 v68, v88 offset:1024
    s_waitcnt lgkmcnt(0)
    v_mov_b32 v90, 0
    v_mov_b32 v91, 1
    s_mov_b64 exec, 1
    ds_add_u32 v90, v91 offset:512
    s_mov_b64 exec, -1
    s_add_u32 s96, s96, 4
.L19:
    ds_read_b32 v91, v90 offset:512
    s_waitcnt lgkmcnt(0)
    v_readfirstlane_b32 s71, v91
    s_nop 0
    s_cmp_lt_u32 s71, s96
    s_nop 2
    s_cbranch_scc1 .L19
    v_lshrrev_b32 v87, 4, v0
    v_lshlrev_b32 v87, 6, v87
    v_mov_b32 v68, 0
    v_mov_b32 v69, 0
    v_mov_b32 v70, 0
    v_mov_b32 v71, 0
    v_mov_b32 v72, 0
    v_mov_b32 v73, 0
    v_mov_b32 v74, 0
    v_mov_b32 v75, 0
    ds_read_b128 v[76:79], v87 offset:1024
    ds_read_b128 v[80:83], v87 offset:1040
    s_waitcnt vmcnt(16) lgkmcnt(0)
    s_call_b64 s[86:87], .Lgemv_92
    ds_read_b128 v[76:79], v87 offset:1056
    ds_read_b128 v[80:83], v87 offset:1072
    s_waitcnt vmcnt(0) lgkmcnt(0)
    s_call_b64 s[86:87], .Lgemv_4
    v_lshlrev_b32 v84, 5, v0
    ds_write_b128 v84, v[68:71] offset:8192
    ds_write_b128 v84, v[72:75] offset:8208
    v_and_b32 v86, 127, v0
    v_lshlrev_b32 v86, 2, v86
    s_waitcnt lgkmcnt(0)
    v_mov_b32 v90, 0
    v_mov_b32 v91, 1
    s_mov_b64 exec, 1
    ds_add_u32 v90, v91 offset:512
    s_mov_b64 exec, -1
    s_add_u32 s96, s96, 4
.L20:
    ds_read_b32 v91, v90 offset:512
    s_waitcnt lgkmcnt(0)
    v_readfirstlane_b32 s71, v91
    s_nop 0
    s_cmp_lt_u32 s71, s96
    s_nop 2
    s_cbranch_scc1 .L20
    ds_read_b32 v68, v86 offset:8192
    ds_read_b32 v69, v86 offset:8704
    ds_read_b32 v70, v86 offset:9216
    ds_read_b32 v71, v86 offset:9728
    ds_read_b32 v72, v86 offset:10240
    ds_read_b32 v73, v86 offset:10752
    ds_read_b32 v74, v86 offset:11264
    ds_read_b32 v75, v86 offset:11776
    ds_read_b32 v76, v86 offset:12288
    ds_read_b32 v77, v86 offset:12800
    ds_read_b32 v78, v86 offset:13312
    ds_read_b32 v79, v86 offset:13824
    ds_read_b32 v80, v86 offset:14336
    ds_read_b32 v81, v86 offset:14848
    ds_read_b32 v82, v86 offset:15360
    ds_read_b32 v83, v86 offset:15872
    s_waitcnt lgkmcnt(0)
    v_add_f32 v68, v68, v76
    v_add_f32 v69, v69, v77
    v_add_f32 v70, v70, v78
    v_add_f32 v71, v71, v79
    v_add_f32 v72, v72, v80
    v_add_f32 v73, v73, v81
    v_add_f32 v74, v74, v82
    v_add_f32 v75, v75, v83
    v_add_f32 v68, v68, v72
    v_add_f32 v69, v69, v73
    v_add_f32 v70, v70, v74
    v_add_f32 v71, v71, v75
    v_add_f32 v68, v68, v70
    v_add_f32 v69, v69, v71
    v_add_f32 v84, v68, v69
    v_mov_b32 v89, v84
    v_and_b32 v86, 127, v0
    s_cmp_lg_u32 s93, 0
    s_nop 1
    s_cbranch_scc1 .L21
    v_cvt_pk_bf16_f32 v84, v84, v84
    v_lshlrev_b32 v86, 1, v86
    ds_write_b16 v86, v84 offset:2048
    s_nop 1
    s_setpc_b64 s[84:85]
.L21:
    s_cmp_lg_u32 s88, 0
    s_cbranch_scc1 .L22
    v_mov_b32 v90, 0
    s_nop 2
.L23:
    ds_read_b32 v91, v90 offset:528
    s_waitcnt lgkmcnt(0)
    v_readfirstlane_b32 s97, v91
    s_nop 0
    s_cmp_eq_u32 s97, 0
    s_nop 2
    s_cbranch_scc1 .L23
.L22:
    s_add_u32 s72, s97, s88
    v_mov_b32 v85, s72
    v_lshlrev_b32 v86, 3, v86
    s_lshl_b32 s61, s94, 10
    s_add_u32 s61, s61, s92
    s_add_u32 s62, s61, 4194304
    buffer_store_dwordx2 v[84:85], v86, s[40:43], s62 offen
    buffer_store_dwordx2 v[84:85], v86, s[40:43], s61 offen sc1
    s_lshl_b32 s61, s95, 12
    s_add_u32 s61, s61, s92
    v_lshlrev_b32 v86, 4, v0
    s_mov_b32 s71, 0
    s_nop 1
.L24:
    s_and_b32 s62, s71, 3
    s_cmp_eq_u32 s62, 3
    s_cselect_b32 s62, 0, 4194304
    s_add_u32 s62, s62, s61
    buffer_load_dwordx4 v[68:71], v86, s[40:43], s62 offen sc1
    s_waitcnt vmcnt(0)
    v_cmp_ne_u32 vcc, s72, v69
    s_nop 1
    v_cndmask_b32 v88, 0, 1, vcc
    v_cmp_ne_u32 vcc, s72, v71
    s_nop 1
    v_cndmask_b32 v89, 0, 1, vcc
    v_or_b32 v91, v88, v89
    v_and_b32 v91, 1, v91
    v_cmp_ne_u32 vcc, 0, v91
    s_nop 0
    s_cmp_eq_u64 vcc, 0
    s_nop 2
    s_cbranch_scc1 .L25
    s_sleep 1
    s_add_u32 s71, s71, 1
    s_cmp_lt_u32 s71, 131072
    s_cbranch_scc1 .L24
.L25:
    v_cvt_pk_bf16_f32 v84, v68, v70
    v_lshlrev_b32 v86, 2, v0
    ds_write_b32 v86, v84 offset:2048
    s_nop 1
    s_setpc_b64 s[84:85]
.Lmain:
    v_mov_b32 v4, 0
    ds_write_b32 v4, v4 offset:512
    ds_write_b32 v4, v4 offset:516
    ds_write_b32 v4, v4 offset:520
    ds_write_b32 v4, v4 offset:528
    ds_write_b32 v4, v4 offset:532
    s_mov_b32 s96, 0
    s_waitcnt lgkmcnt(0)
    s_barrier
    s_mov_b32 s88, 0
    s_mov_b32 s93, 1
    s_mov_b32 s92, 3145728
    s_mov_b32 s80, s24
    s_mov_b32 s81, s25
    s_mov_b32 s82, s26
    s_mov_b32 s83, 0x00020000
    s_mov_b32 s98, 0
    s_cmp_ge_u32 s60, 4
    s_cbranch_scc1 .L26
    s_lshl_b32 s61, s56, 10
    v_lshlrev_b32 v255, 2, v0
    buffer_load_dword v84, v255, s[44:47], s61 offen
    v_and_b32 v255, 15, v0
    v_lshrrev_b32 v254, 4, v0
    v_lshlrev_b32 v254, 18, v254
    s_lshl_b32 s70, s59, 8
    v_lshl_add_u32 v254, v255, 4, v254
    s_add_u32 s61, s70, 0
    buffer_load_dwordx4 v[92:95], v254, s[80:83], s61 offen offset:0
    s_add_u32 s61, s70, 8192
    buffer_load_dwordx4 v[96:99], v254, s[80:83], s61 offen offset:0
    s_add_u32 s61, s70, 16384
    buffer_load_dwordx4 v[100:103], v254, s[80:83], s61 offen offset:0
    s_add_u32 s61, s70, 24576
    buffer_load_dwordx4 v[104:107], v254, s[80:83], s61 offen offset:0
    s_add_u32 s61, s70, 32768
    buffer_load_dwordx4 v[108:111], v254, s[80:83], s61 offen offset:0
    s_add_u32 s61, s70, 40960
    buffer_load_dwordx4 v[112:115], v254, s[80:83], s61 offen offset:0
    s_add_u32 s61, s70, 49152
    buffer_load_dwordx4 v[116:119], v254, s[80:83], s61 offen offset:0
    s_add_u32 s61, s70, 57344
    buffer_load_dwordx4 v[120:123], v254, s[80:83], s61 offen offset:0
    s_add_u32 s61, s70, 65536
    buffer_load_dwordx4 v[124:127], v254, s[80:83], s61 offen offset:0
    s_add_u32 s61, s70, 73728
    buffer_load_dwordx4 v[128:131], v254, s[80:83], s61 offen offset:0
    s_add_u32 s61, s70, 81920
    buffer_load_dwordx4 v[132:135], v254, s[80:83], s61 offen offset:0
    s_add_u32 s61, s70, 90112
    buffer_load_dwordx4 v[136:139], v254, s[80:83], s61 offen offset:0
    s_add_u32 s61, s70, 98304
    buffer_load_dwordx4 v[140:143], v254, s[80:83], s61 offen offset:0
    s_add_u32 s61, s70, 106496
    buffer_load_dwordx4 v[144:147], v254, s[80:83], s61 offen offset:0
    s_add_u32 s61, s70, 114688
    buffer_load_dwordx4 v[148:151], v254, s[80:83], s61 offen offset:0
    s_add_u32 s61, s70, 122880
    buffer_load_dwordx4 v[152:155], v254, s[80:83], s61 offen offset:0
    s_add_u32 s61, s70, 131072
    buffer_load_dwordx4 v[4:7], v254, s[80:83], s61 offen offset:0
    s_add_u32 s61, s70, 139264
    buffer_load_dwordx4 v[8:11], v254, s[80:83], s61 offen offset:0
    s_add_u32 s61, s70, 147456
    buffer_load_dwordx4 v[12:15], v254, s[80:83], s61 offen offset:0
    s_add_u32 s61, s70, 155648
    buffer_load_dwordx4 v[16:19], v254, s[80:83], s61 offen offset:0
    s_add_u32 s61, s70, 163840
    buffer_load_dwordx4 v[20:23], v254, s[80:83], s61 offen offset:0
    s_add_u32 s61, s70, 172032
    buffer_load_dwordx4 v[24:27], v254, s[80:83], s61 offen offset:0
    s_add_u32 s61, s70, 180224
    buffer_load_dwordx4 v[28:31], v254, s[80:83], s61 offen offset:0
    s_add_u32 s61, s70, 188416
    buffer_load_dwordx4 v[32:35], v254, s[80:83], s61 offen offset:0
    s_add_u32 s61, s70, 196608
    buffer_load_dwordx4 v[36:39], v254, s[80:83], s61 offen offset:0
    s_add_u32 s61, s70, 204800
    buffer_load_dwordx4 v[40:43], v254, s[80:83], s61 offen offset:0
    s_add_u32 s61, s70, 212992
    buffer_load_dwordx4 v[44:47], v254, s[80:83], s61 offen offset:0
    s_add_u32 s61, s70, 221184
    buffer_load_dwordx4 v[48:51], v254, s[80:83], s61 offen offset:0
    s_add_u32 s61, s70, 229376
    buffer_load_dwordx4 v[52:55], v254, s[80:83], s61 offen offset:0
    s_add_u32 s61, s70, 237568
    buffer_load_dwordx4 v[56:59], v254, s[80:83], s61 offen offset:0
    s_add_u32 s61, s70, 245760
    buffer_load_dwordx4 v[60:63], v254, s[80:83], s61 offen offset:0
    s_add_u32 s61, s70, 253952
    buffer_load_dwordx4 v[64:67], v254, s[80:83], s61 offen offset:0
    s_waitcnt vmcnt(32)
    v_lshlrev_b32 v252, 16, v84
    v_and_b32 v253, s69, v84
    s_nop 2
    s_call_b64 s[84:85], .Lqpart
    s_cmp_ge_u32 s56, 4
    s_cbranch_scc0 .L28
    s_cmp_lg_u32 s60, 0
    s_cbranch_scc1 .L29
    v_mov_b32 v90, 0
    ds_read_b32 v87, v90 offset:532
    s_lshl_b32 s62, s2, 2
    s_add_u32 s62, s62, 11776
    v_mov_b32 v89, 0
    s_waitcnt lgkmcnt(0)
    s_mov_b32 s71, 0
    s_nop 0
.L30:
    buffer_load_dword v86, v90, s[40:43], s62 offen sc1
    s_waitcnt vmcnt(0)
    v_cmp_ne_u32 vcc, v86, v87
    s_nop 1
    v_cndmask_b32 v88, 0, 1, vcc
    v_or_b32 v91, v88, v89
    v_and_b32 v91, 1, v91
    v_cmp_ne_u32 vcc, 0, v91
    s_nop 0
    s_cmp_eq_u64 vcc, 0
    s_nop 2
    s_cbranch_scc1 .L31
    s_sleep 4
    s_add_u32 s71, s71, 1
    s_cmp_lt_u32 s71, 131072
    s_cbranch_scc1 .L30
.L31:
.L29:
.L28:
    s_waitcnt lgkmcnt(0)
    v_mov_b32 v90, 0
    v_mov_b32 v91, 1
    s_mov_b64 exec, 1
    ds_add_u32 v90, v91 offset:512
    s_mov_b64 exec, -1
    s_add_u32 s96, s96, 4
.L32:
    ds_read_b32 v91, v90 offset:512
    s_waitcnt lgkmcnt(0)
    v_readfirstlane_b32 s71, v91
    s_nop 0
    s_cmp_lt_u32 s71, s96
    s_nop 2
    s_cbranch_scc1 .L32
    v_mov_b32 v91, 1
    ds_write_b32 v90, v91 offset:520
    s_mov_b32 s61, 0
    buffer_load_dwordx4 v[156:159], v1, s[8:11], s61 offen offset:0 nt
    buffer_load_dwordx4 v[160:163], v1, s[8:11], s61 offen offset:1024 nt
    buffer_load_dwordx4 v[164:167], v1, s[8:11], s61 offen offset:2048 nt
    buffer_load_dwordx4 v[168:171], v1, s[8:11], s61 offen offset:3072 nt
    s_mov_b32 s61, 0
    buffer_load_dwordx4 v[92:95], v1, s[12:15], s61 offen offset:0 nt
    buffer_load_dwordx4 v[96:99], v1, s[12:15], s61 offen offset:1024 nt
    buffer_load_dwordx4 v[100:103], v1, s[12:15], s61 offen offset:2048 nt
    buffer_load_dwordx4 v[104:107], v1, s[12:15], s61 offen offset:3072 nt
    s_mov_b32 s61, 4096
    buffer_load_dwordx4 v[172:175], v1, s[8:11], s61 offen offset:0 nt
    buffer_load_dwordx4 v[176:179], v1, s[8:11], s61 offen offset:1024 nt
    buffer_load_dwordx4 v[180:183], v1, s[8:11], s61 offen offset:2048 nt
    buffer_load_dwordx4 v[184:187], v1, s[8:11], s61 offen offset:3072 nt
    s_mov_b32 s61, 4096
    buffer_load_dwordx4 v[108:111], v1, s[12:15], s61 offen offset:0 nt
    buffer_load_dwordx4 v[112:115], v1, s[12:15], s61 offen offset:1024 nt
    buffer_load_dwordx4 v[116:119], v1, s[12:15], s61 offen offset:2048 nt
    buffer_load_dwordx4 v[120:123], v1, s[12:15], s61 offen offset:3072 nt
    s_branch .L27
.L26:
    v_mov_b32 v8, 0
    s_cmp_lg_u32 s60, 6
    s_nop 1
    s_cbranch_scc1 .L33
    s_getpc_b64 s[72:73]
.Lpcref:
    s_sub_u32 s72, s72, .Lpcref-interleave_layers__gqa_block_cached__mha_block_cached__decode_kernel
    s_subb_u32 s73, s73, 0
    v_and_b32 v9, 63, v0
    v_lshlrev_b32 v9, 7, v9
    global_load_dword v10, v9, s[72:73]
    v_add_u32 v9, 0x2000, v9
    global_load_dword v11, v9, s[72:73]
    v_add_u32 v9, 0x2000, v9
    global_load_dword v12, v9, s[72:73]
    v_add_u32 v9, 0x2000, v9
    s_nop 2
.L33:
    s_and_b32 s61, s2, 31
    s_cmp_lg_u32 s61, 0
    s_cbranch_scc1 .L34
    s_cmp_lg_u32 s60, 4
    s_cbranch_scc1 .L34
    s_memrealtime s[74:75]
    s_waitcnt lgkmcnt(0)
    s_lshl_b32 s61, s74, 3
    s_or_b32 s61, s61, 1
    v_mov_b32 v9, s61
    s_lshl_b32 s62, s56, 2
    s_add_u32 s62, s62, 64
    buffer_store_dword v9, v8, s[52:55], s62 offen sc1
.L34:
    s_cmp_lg_u32 s60, 5
    s_cbranch_scc1 .L35
    v_and_b32 v10, 1, v0
    v_lshlrev_b32 v11, 4, v10
    s_lshl_b32 s62, s56, 2
    v_xor_b32 v11, s62, v11
    v_lshlrev_b32 v10, 2, v10
    s_mov_b32 s71, 0
    s_nop 1
.L36:
    buffer_load_dword v12, v11, s[52:55], 0 offen offset:64 sc1
    s_waitcnt vmcnt(0)
    v_cmp_eq_u32 vcc, 0, v12
    s_nop 1
    v_cndmask_b32 v88, 0, 1, vcc
    v_mov_b32 v89, 0
    v_or_b32 v91, v88, v89
    v_and_b32 v91, 1, v91
    v_cmp_ne_u32 vcc, 0, v91
    s_nop 0
    s_cmp_eq_u64 vcc, 0
    s_nop 2
    s_cbranch_scc1 .L37
    s_sleep 4
    s_add_u32 s71, s71, 1
    s_cmp_lt_u32 s71, 131072
    s_cbranch_scc1 .L36
.L37:
    ds_write_b32 v10, v12 offset:528
.L35:
    v_and_b32 v4, 255, v0
    v_lshlrev_b32 v5, 3, v4
    v_mov_b32 v6, -1
    v_mov_b32 v7, -1
    s_lshl_b32 s61, s94, 11
    s_add_u32 s62, s61, 65536
    buffer_store_dwordx2 v[6:7], v5, s[40:43], s62 offen sc1
    s_add_u32 s62, s61, 589824
    buffer_store_dwordx2 v[6:7], v5, s[40:43], s62 offen sc1
    s_add_u32 s62, s61, 1114112
    buffer_store_dwordx2 v[6:7], v5, s[40:43], s62 offen sc1
    s_add_u32 s62, s61, 1638400
    buffer_store_dwordx2 v[6:7], v5, s[40:43], s62 offen sc1
    s_lshl_b32 s61, s95, 2
    s_add_u32 s61, s61, s58
    v_and_b32 v9, 7, v0
    v_lshlrev_b32 v9, 2, v9
    s_lshl_b32 s62, s61, 11
    s_add_u32 s62, s62, 4194304
    buffer_store_dwordx2 v[6:7], v5, s[40:43], s62 offen sc1
    s_add_u32 s62, s62, 4194304
    buffer_store_dwordx2 v[6:7], v5, s[40:43], s62 offen sc1
    s_lshl_b32 s62, s61, 5
    s_add_u32 s62, s62, 5242880
    buffer_store_dword v6, v9, s[40:43], s62 offen sc1
    s_add_u32 s62, s62, 4194304
    buffer_store_dword v6, v9, s[40:43], s62 offen sc1
    s_lshl_b32 s62, s61, 11
    s_add_u32 s62, s62, 4718592
    buffer_store_dwordx2 v[6:7], v5, s[40:43], s62 offen sc1
    s_add_u32 s62, s62, 4194304
    buffer_store_dwordx2 v[6:7], v5, s[40:43], s62 offen sc1
    s_lshl_b32 s62, s61, 5
    s_add_u32 s62, s62, 5308416
    buffer_store_dword v6, v9, s[40:43], s62 offen sc1
    s_add_u32 s62, s62, 4194304
    buffer_store_dword v6, v9, s[40:43], s62 offen sc1
    s_cmp_ge_u32 s56, 4
    s_cbranch_scc1 .L38
    s_mov_b32 s61, 0
    buffer_load_dwordx4 v[156:159], v1, s[8:11], s61 offen offset:0 nt
    buffer_load_dwordx4 v[160:163], v1, s[8:11], s61 offen offset:1024 nt
    buffer_load_dwordx4 v[164:167], v1, s[8:11], s61 offen offset:2048 nt
    buffer_load_dwordx4 v[168:171], v1, s[8:11], s61 offen offset:3072 nt
    s_mov_b32 s61, 0
    buffer_load_dwordx4 v[92:95], v1, s[12:15], s61 offen offset:0 nt
    buffer_load_dwordx4 v[96:99], v1, s[12:15], s61 offen offset:1024 nt
    buffer_load_dwordx4 v[100:103], v1, s[12:15], s61 offen offset:2048 nt
    buffer_load_dwordx4 v[104:107], v1, s[12:15], s61 offen offset:3072 nt
    s_mov_b32 s61, 4096
    buffer_load_dwordx4 v[172:175], v1, s[8:11], s61 offen offset:0 nt
    buffer_load_dwordx4 v[176:179], v1, s[8:11], s61 offen offset:1024 nt
    buffer_load_dwordx4 v[180:183], v1, s[8:11], s61 offen offset:2048 nt
    buffer_load_dwordx4 v[184:187], v1, s[8:11], s61 offen offset:3072 nt
    s_mov_b32 s61, 4096
    buffer_load_dwordx4 v[108:111], v1, s[12:15], s61 offen offset:0 nt
    buffer_load_dwordx4 v[112:115], v1, s[12:15], s61 offen offset:1024 nt
    buffer_load_dwordx4 v[116:119], v1, s[12:15], s61 offen offset:2048 nt
    buffer_load_dwordx4 v[120:123], v1, s[12:15], s61 offen offset:3072 nt
    s_waitcnt vmcnt(8)
    s_mov_b32 s61, 8192
    buffer_load_dwordx4 v[188:191], v1, s[8:11], s61 offen offset:0 nt
    buffer_load_dwordx4 v[192:195], v1, s[8:11], s61 offen offset:1024 nt
    buffer_load_dwordx4 v[196:199], v1, s[8:11], s61 offen offset:2048 nt
    buffer_load_dwordx4 v[200:203], v1, s[8:11], s61 offen offset:3072 nt
    s_mov_b32 s61, 8192
    buffer_load_dwordx4 v[124:127], v1, s[12:15], s61 offen offset:0 nt
    buffer_load_dwordx4 v[128:131], v1, s[12:15], s61 offen offset:1024 nt
    buffer_load_dwordx4 v[132:135], v1, s[12:15], s61 offen offset:2048 nt
    buffer_load_dwordx4 v[136:139], v1, s[12:15], s61 offen offset:3072 nt
    s_waitcnt vmcnt(8)
    s_mov_b32 s61, 12288
    buffer_load_dwordx4 v[204:207], v1, s[8:11], s61 offen offset:0 nt
    buffer_load_dwordx4 v[208:211], v1, s[8:11], s61 offen offset:1024 nt
    buffer_load_dwordx4 v[212:215], v1, s[8:11], s61 offen offset:2048 nt
    buffer_load_dwordx4 v[216:219], v1, s[8:11], s61 offen offset:3072 nt
    s_mov_b32 s61, 12288
    buffer_load_dwordx4 v[236:239], v1, s[12:15], s61 offen offset:0 nt
    buffer_load_dwordx4 v[240:243], v1, s[12:15], s61 offen offset:1024 nt
    buffer_load_dwordx4 v[244:247], v1, s[12:15], s61 offen offset:2048 nt
    buffer_load_dwordx4 v[248:251], v1, s[12:15], s61 offen offset:3072 nt
    s_waitcnt vmcnt(8)
    s_mov_b32 s61, 16384
    buffer_load_dwordx4 v[220:223], v1, s[8:11], s61 offen offset:0 nt
    buffer_load_dwordx4 v[224:227], v1, s[8:11], s61 offen offset:1024 nt
    buffer_load_dwordx4 v[228:231], v1, s[8:11], s61 offen offset:2048 nt
    buffer_load_dwordx4 v[232:235], v1, s[8:11], s61 offen offset:3072 nt
    s_mov_b32 s61, 16384
    buffer_load_dwordx4 v[140:143], v1, s[12:15], s61 offen offset:0 nt
    buffer_load_dwordx4 v[144:147], v1, s[12:15], s61 offen offset:1024 nt
    buffer_load_dwordx4 v[148:151], v1, s[12:15], s61 offen offset:2048 nt
    buffer_load_dwordx4 v[152:155], v1, s[12:15], s61 offen offset:3072 nt
    s_mov_b32 s98, 1
.L38:
    v_mov_b32 v90, 0
    s_nop 2
.L39:
    ds_read_b32 v91, v90 offset:520
    s_waitcnt lgkmcnt(0)
    v_readfirstlane_b32 s71, v91
    s_sleep 1
    s_cmp_lt_u32 s71, 1
    s_nop 2
    s_cbranch_scc1 .L39
    s_cmp_ge_u32 s56, 4
    s_cbranch_scc0 .L40
    s_mov_b32 s61, 0
    buffer_load_dwordx4 v[156:159], v1, s[8:11], s61 offen offset:0 nt
    buffer_load_dwordx4 v[160:163], v1, s[8:11], s61 offen offset:1024 nt
    buffer_load_dwordx4 v[164:167], v1, s[8:11], s61 offen offset:2048 nt
    buffer_load_dwordx4 v[168:171], v1, s[8:11], s61 offen offset:3072 nt
    s_mov_b32 s61, 0
    buffer_load_dwordx4 v[92:95], v1, s[12:15], s61 offen offset:0 nt
    buffer_load_dwordx4 v[96:99], v1, s[12:15], s61 offen offset:1024 nt
    buffer_load_dwordx4 v[100:103], v1, s[12:15], s61 offen offset:2048 nt
    buffer_load_dwordx4 v[104:107], v1, s[12:15], s61 offen offset:3072 nt
    s_mov_b32 s61, 4096
    buffer_load_dwordx4 v[172:175], v1, s[8:11], s61 offen offset:0 nt
    buffer_load_dwordx4 v[176:179], v1, s[8:11], s61 offen offset:1024 nt
    buffer_load_dwordx4 v[180:183], v1, s[8:11], s61 offen offset:2048 nt
    buffer_load_dwordx4 v[184:187], v1, s[8:11], s61 offen offset:3072 nt
    s_mov_b32 s61, 4096
    buffer_load_dwordx4 v[108:111], v1, s[12:15], s61 offen offset:0 nt
    buffer_load_dwordx4 v[112:115], v1, s[12:15], s61 offen offset:1024 nt
    buffer_load_dwordx4 v[116:119], v1, s[12:15], s61 offen offset:2048 nt
    buffer_load_dwordx4 v[120:123], v1, s[12:15], s61 offen offset:3072 nt
.L40:
.L27:
    v_and_b32 v84, 15, v0
    v_bfe_u32 v85, v0, 4, 2
    s_add_u32 s61, s99, 8192
    v_xor_b32 v86, v84, v85
    v_lshlrev_b32 v86, 4, v86
    v_lshl_add_u32 v53, v85, 8, v86
    v_add_u32 v53, s61, v53
    v_lshl_add_u32 v54, v84, 8, v86
    v_add_u32 v54, s61, v54
    v_lshlrev_b32 v86, 1, v85
    v_xor_b32 v86, v86, v84
    v_lshlrev_b32 v86, 4, v86
    v_lshl_add_u32 v55, v85, 8, v86
    v_lshrrev_b32 v86, 2, v84
    v_lshl_add_u32 v86, v85, 2, v86
    v_and_b32 v87, 7, v86
    v_lshlrev_b32 v87, 1, v87
    v_bfe_u32 v88, v84, 1, 1
    v_xor_b32 v87, v87, v88
    v_lshlrev_b32 v87, 4, v87
    v_lshl_add_u32 v87, v86, 8, v87
    v_and_b32 v88, 1, v84
    v_lshl_add_u32 v57, v88, 3, v87
    v_mov_b32 v4, 0
    v_mov_b32 v5, 0
    v_mov_b32 v6, 0
    v_mov_b32 v7, 0
    v_mov_b32 v8, 0
    v_mov_b32 v9, 0
    v_mov_b32 v10, 0
    v_mov_b32 v11, 0
    v_mov_b32 v12, 0
    v_mov_b32 v13, 0
    v_mov_b32 v14, 0
    v_mov_b32 v15, 0
    v_mov_b32 v16, 0
    v_mov_b32 v17, 0
    v_mov_b32 v18, 0
    v_mov_b32 v19, 0
    v_lshlrev_b32 v86, 8, v84
    v_lshl_add_u32 v86, v85, 4, v86
    s_mov_b32 s61, 0x000f000f
    s_mov_b32 exec_lo, s61
    s_mov_b32 exec_hi, s61
    ds_read_b128 v[4:7], v86 offset:2048
    ds_read_b128 v[8:11], v86 offset:2112
    ds_read_b128 v[12:15], v86 offset:2176
    ds_read_b128 v[16:19], v86 offset:2240
    s_mov_b64 exec, -1
    v_mov_b32 v20, 0
    v_mov_b32 v21, 0
    v_mov_b32 v22, 0
    v_mov_b32 v23, 0
    v_mov_b32 v24, 0
    v_mov_b32 v25, 0
    v_mov_b32 v26, 0
    v_mov_b32 v27, 0
    v_mov_b32 v28, 0
    v_mov_b32 v29, 0
    v_mov_b32 v30, 0
    v_mov_b32 v31, 0
    v_mov_b32 v32, 0
    v_mov_b32 v33, 0
    v_mov_b32 v34, 0
    v_mov_b32 v35, 0
    v_mov_b32 v36, 0
    v_mov_b32 v37, 0
    v_mov_b32 v38, 0
    v_mov_b32 v39, 0
    v_mov_b32 v40, 0
    v_mov_b32 v41, 0
    v_mov_b32 v42, 0
    v_mov_b32 v43, 0
    v_mov_b32 v44, 0
    v_mov_b32 v45, 0
    v_mov_b32 v46, 0
    v_mov_b32 v47, 0
    v_mov_b32 v48, 0
    v_mov_b32 v49, 0
    v_mov_b32 v50, 0
    v_mov_b32 v51, 0
    v_mov_b32 v52, 0xf149f2ca
    v_mov_b32 v56, 0
    s_waitcnt lgkmcnt(0)
    s_waitcnt vmcnt(12)
    s_nop 0
    s_call_b64 s[84:85], .LstK_156
    s_add_u32 s100, s101, 0
    s_waitcnt vmcnt(8)
    s_call_b64 s[84:85], .LvwA_92
    s_cmp_lt_u32 s60, 4
    s_cbranch_scc1 .L41
    v_mov_b32 v84, 0
    v_mov_b32 v85, 1
    s_mov_b64 exec, 1
    ds_add_rtn_u32 v86, v84, v85 offset:516
    s_waitcnt lgkmcnt(0)
    v_readfirstlane_b32 s61, v86
    s_mov_b64 exec, -1
    s_cmp_lg_u32 s61, 3
    s_nop 2
    s_cbranch_scc1 .L42
    s_lshl_b32 s62, s56, 2
    s_mov_b64 exec, 1
    buffer_atomic_add v85, v84, s[52:55], s62 offen sc1
    s_mov_b64 exec, -1
.L42:
.L41:
    s_cmp_lg_u32 s98, 0
    s_cbranch_scc1 .L43
    s_mov_b32 s61, 8192
    buffer_load_dwordx4 v[188:191], v1, s[8:11], s61 offen offset:0 nt
    buffer_load_dwordx4 v[192:195], v1, s[8:11], s61 offen offset:1024 nt
    buffer_load_dwordx4 v[196:199], v1, s[8:11], s61 offen offset:2048 nt
    buffer_load_dwordx4 v[200:203], v1, s[8:11], s61 offen offset:3072 nt
    s_mov_b32 s61, 8192
    buffer_load_dwordx4 v[124:127], v1, s[12:15], s61 offen offset:0 nt
    buffer_load_dwordx4 v[128:131], v1, s[12:15], s61 offen offset:1024 nt
    buffer_load_dwordx4 v[132:135], v1, s[12:15], s61 offen offset:2048 nt
    buffer_load_dwordx4 v[136:139], v1, s[12:15], s61 offen offset:3072 nt
.L43:
    s_waitcnt vmcnt(12)
    s_call_b64 s[84:85], .LstK_172
    s_add_u32 s100, s101, 4096
    s_waitcnt vmcnt(8)
    s_call_b64 s[84:85], .LvwA_108
    s_cmp_lg_u32 s98, 0
    s_cbranch_scc1 .L44
    s_mov_b32 s61, 12288
    buffer_load_dwordx4 v[204:207], v1, s[8:11], s61 offen offset:0 nt
    buffer_load_dwordx4 v[208:211], v1, s[8:11], s61 offen offset:1024 nt
    buffer_load_dwordx4 v[212:215], v1, s[8:11], s61 offen offset:2048 nt
    buffer_load_dwordx4 v[216:219], v1, s[8:11], s61 offen offset:3072 nt
    s_mov_b32 s61, 12288
    buffer_load_dwordx4 v[236:239], v1, s[12:15], s61 offen offset:0 nt
    buffer_load_dwordx4 v[240:243], v1, s[12:15], s61 offen offset:1024 nt
    buffer_load_dwordx4 v[244:247], v1, s[12:15], s61 offen offset:2048 nt
    buffer_load_dwordx4 v[248:251], v1, s[12:15], s61 offen offset:3072 nt
.L44:
    s_waitcnt vmcnt(12)
    s_call_b64 s[84:85], .LstK_188
    s_add_u32 s100, s101, 8192
    s_waitcnt vmcnt(8)
    s_call_b64 s[84:85], .LvwA_124
    s_cmp_lg_u32 s98, 0
    s_cbranch_scc1 .L45
    s_mov_b32 s61, 16384
    buffer_load_dwordx4 v[220:223], v1, s[8:11], s61 offen offset:0 nt
    buffer_load_dwordx4 v[224:227], v1, s[8:11], s61 offen offset:1024 nt
    buffer_load_dwordx4 v[228:231], v1, s[8:11], s61 offen offset:2048 nt
    buffer_load_dwordx4 v[232:235], v1, s[8:11], s61 offen offset:3072 nt
    s_mov_b32 s61, 16384
    buffer_load_dwordx4 v[140:143], v1, s[12:15], s61 offen offset:0 nt
    buffer_load_dwordx4 v[144:147], v1, s[12:15], s61 offen offset:1024 nt
    buffer_load_dwordx4 v[148:151], v1, s[12:15], s61 offen offset:2048 nt
    buffer_load_dwordx4 v[152:155], v1, s[12:15], s61 offen offset:3072 nt
.L45:
    s_waitcnt vmcnt(12)
    s_call_b64 s[84:85], .LstK_204
    s_add_u32 s100, s99, 8192
    s_waitcnt vmcnt(8)
    s_call_b64 s[84:85], .LvwA_236
    s_mov_b32 s61, 20480
    buffer_load_dwordx4 v[92:95], v1, s[8:11], s61 offen offset:0 nt
    buffer_load_dwordx4 v[96:99], v1, s[8:11], s61 offen offset:1024 nt
    buffer_load_dwordx4 v[100:103], v1, s[8:11], s61 offen offset:2048 nt
    buffer_load_dwordx4 v[104:107], v1, s[8:11], s61 offen offset:3072 nt
    s_mov_b32 s61, 20480
    buffer_load_dwordx4 v[108:111], v1, s[12:15], s61 offen offset:0 nt
    buffer_load_dwordx4 v[112:115], v1, s[12:15], s61 offen offset:1024 nt
    buffer_load_dwordx4 v[116:119], v1, s[12:15], s61 offen offset:2048 nt
    buffer_load_dwordx4 v[120:123], v1, s[12:15], s61 offen offset:3072 nt
    s_waitcnt vmcnt(12)
    s_call_b64 s[84:85], .LstK_220
    s_add_u32 s100, s99, 8192
    s_waitcnt vmcnt(8)
    s_call_b64 s[84:85], .LvwA_140
    s_mov_b32 s61, 24576
    buffer_load_dwordx4 v[124:127], v1, s[8:11], s61 offen offset:0 nt
    buffer_load_dwordx4 v[128:131], v1, s[8:11], s61 offen offset:1024 nt
    buffer_load_dwordx4 v[132:135], v1, s[8:11], s61 offen offset:2048 nt
    buffer_load_dwordx4 v[136:139], v1, s[8:11], s61 offen offset:3072 nt
    s_mov_b32 s61, 24576
    buffer_load_dwordx4 v[140:143], v1, s[12:15], s61 offen offset:0 nt
    buffer_load_dwordx4 v[144:147], v1, s[12:15], s61 offen offset:1024 nt
    buffer_load_dwordx4 v[148:151], v1, s[12:15], s61 offen offset:2048 nt
    buffer_load_dwordx4 v[152:155], v1, s[12:15], s61 offen offset:3072 nt
    s_waitcnt vmcnt(12)
    s_call_b64 s[84:85], .LstK_92
    s_add_u32 s100, s99, 8192
    s_waitcnt vmcnt(8)
    s_call_b64 s[84:85], .LvwA_108
    s_mov_b32 s61, 28672
    buffer_load_dwordx4 v[92:95], v1, s[8:11], s61 offen offset:0 nt
    buffer_load_dwordx4 v[96:99], v1, s[8:11], s61 offen offset:1024 nt
    buffer_load_dwordx4 v[100:103], v1, s[8:11], s61 offen offset:2048 nt
    buffer_load_dwordx4 v[104:107], v1, s[8:11], s61 offen offset:3072 nt
    s_mov_b32 s61, 28672
    buffer_load_dwordx4 v[108:111], v1, s[12:15], s61 offen offset:0 nt
    buffer_load_dwordx4 v[112:115], v1, s[12:15], s61 offen offset:1024 nt
    buffer_load_dwordx4 v[116:119], v1, s[12:15], s61 offen offset:2048 nt
    buffer_load_dwordx4 v[120:123], v1, s[12:15], s61 offen offset:3072 nt
    s_waitcnt vmcnt(12)
    s_call_b64 s[84:85], .LstK_124
    s_add_u32 s100, s99, 8192
    s_waitcnt vmcnt(8)
    s_call_b64 s[84:85], .LvwA_140
    s_waitcnt vmcnt(4)
    s_call_b64 s[84:85], .LstK_92
    s_add_u32 s100, s99, 8192
    s_waitcnt vmcnt(0)
    s_call_b64 s[84:85], .LvwA_108
    s_cmp_lg_u32 s60, 7
    s_cbranch_scc1 .L46
    v_mov_b32 v84, 0
    ds_read_b32 v85, v84 offset:528
    s_lshl_b32 s62, s2, 2
    s_add_u32 s62, s62, 12288
    s_waitcnt lgkmcnt(0)
    buffer_store_dword v85, v84, s[40:43], s62 offen sc1
.L46:
    s_call_b64 s[84:85], .LwcombA
    s_mov_b32 s88, 1
    s_mov_b32 s89, 65536
    s_mov_b32 s76, s28
    s_mov_b32 s77, s29
    s_mov_b32 s78, s30
    s_mov_b32 s79, 0x00020000
    s_mov_b32 s90, 4194304
    s_mov_b32 s91, 5242880
    s_mov_b32 s93, 0
    s_mov_b32 s92, 3407872
    s_mov_b32 s80, s32
    s_mov_b32 s81, s33
    s_mov_b32 s82, s34
    s_mov_b32 s83, 0x00020000
    s_cmp_ge_u32 s60, 4
    s_cbranch_scc1 .L47
    s_call_b64 s[84:85], .LcritA
    v_mov_b32 v90, 0
    v_mov_b32 v91, 16
    ds_write_b32 v90, v91 offset:536
    s_waitcnt lgkmcnt(0)
    v_mov_b32 v90, 0
    v_mov_b32 v91, 1
    s_mov_b64 exec, 1
    ds_add_u32 v90, v91 offset:512
    s_mov_b64 exec, -1
    s_add_u32 s96, s96, 4
.L49:
    ds_read_b32 v91, v90 offset:512
    s_waitcnt lgkmcnt(0)
    v_readfirstlane_b32 s71, v91
    s_nop 0
    s_cmp_lt_u32 s71, s96
    s_nop 2
    s_cbranch_scc1 .L49
    v_mov_b32 v91, 2
    ds_write_b32 v90, v91 offset:520
    s_add_u32 s61, s99, 0
    buffer_load_dwordx4 v[92:95], v2, s[16:19], s61 offen offset:0 nt
    buffer_load_dwordx4 v[96:99], v2, s[16:19], s61 offen offset:1024 nt
    buffer_load_dwordx4 v[100:103], v2, s[16:19], s61 offen offset:2048 nt
    buffer_load_dwordx4 v[104:107], v2, s[16:19], s61 offen offset:3072 nt
    buffer_load_dwordx4 v[108:111], v2, s[20:23], s61 offen offset:0 nt
    buffer_load_dwordx4 v[112:115], v2, s[20:23], s61 offen offset:1024 nt
    buffer_load_dwordx4 v[116:119], v2, s[20:23], s61 offen offset:2048 nt
    buffer_load_dwordx4 v[120:123], v2, s[20:23], s61 offen offset:3072 nt
    s_add_u32 s61, s99, 32768
    buffer_load_dwordx4 v[124:127], v2, s[16:19], s61 offen offset:0 nt
    buffer_load_dwordx4 v[128:131], v2, s[16:19], s61 offen offset:1024 nt
    buffer_load_dwordx4 v[132:135], v2, s[16:19], s61 offen offset:2048 nt
    buffer_load_dwordx4 v[136:139], v2, s[16:19], s61 offen offset:3072 nt
    buffer_load_dwordx4 v[140:143], v2, s[20:23], s61 offen offset:0 nt
    buffer_load_dwordx4 v[144:147], v2, s[20:23], s61 offen offset:1024 nt
    buffer_load_dwordx4 v[148:151], v2, s[20:23], s61 offen offset:2048 nt
    buffer_load_dwordx4 v[152:155], v2, s[20:23], s61 offen offset:3072 nt
    s_branch .L48
.L47:
    s_barrier
    s_add_u32 s61, s99, 0
    buffer_load_dwordx4 v[92:95], v2, s[16:19], s61 offen offset:0 nt
    buffer_load_dwordx4 v[96:99], v2, s[16:19], s61 offen offset:1024 nt
    buffer_load_dwordx4 v[100:103], v2, s[16:19], s61 offen offset:2048 nt
    buffer_load_dwordx4 v[104:107], v2, s[16:19], s61 offen offset:3072 nt
    buffer_load_dwordx4 v[108:111], v2, s[20:23], s61 offen offset:0 nt
    buffer_load_dwordx4 v[112:115], v2, s[20:23], s61 offen offset:1024 nt
    buffer_load_dwordx4 v[116:119], v2, s[20:23], s61 offen offset:2048 nt
    buffer_load_dwordx4 v[120:123], v2, s[20:23], s61 offen offset:3072 nt
    s_add_u32 s61, s99, 32768
    buffer_load_dwordx4 v[124:127], v2, s[16:19], s61 offen offset:0 nt
    buffer_load_dwordx4 v[128:131], v2, s[16:19], s61 offen offset:1024 nt
    buffer_load_dwordx4 v[132:135], v2, s[16:19], s61 offen offset:2048 nt
    buffer_load_dwordx4 v[136:139], v2, s[16:19], s61 offen offset:3072 nt
    buffer_load_dwordx4 v[140:143], v2, s[20:23], s61 offen offset:0 nt
    buffer_load_dwordx4 v[144:147], v2, s[20:23], s61 offen offset:1024 nt
    buffer_load_dwordx4 v[148:151], v2, s[20:23], s61 offen offset:2048 nt
    buffer_load_dwordx4 v[152:155], v2, s[20:23], s61 offen offset:3072 nt
    v_mov_b32 v90, 0
    s_nop 2
.L50:
    ds_read_b32 v91, v90 offset:520
    s_waitcnt lgkmcnt(0)
    v_readfirstlane_b32 s71, v91
    s_sleep 1
    s_cmp_lt_u32 s71, 2
    s_nop 2
    s_cbranch_scc1 .L50
.L48:
    v_and_b32 v84, 15, v0
    v_lshlrev_b32 v84, 4, v84
    ds_read_b128 v[4:7], v84 offset:2048
    v_mov_b32 v20, 0
    v_mov_b32 v21, 0
    v_mov_b32 v22, 0
    v_mov_b32 v23, 0
    v_mov_b32 v24, 0
    v_mov_b32 v25, 0
    v_mov_b32 v26, 0
    v_mov_b32 v27, 0
    v_mov_b32 v52, 0xf149f2ca
    v_mov_b32 v56, 0
    s_waitcnt lgkmcnt(0)
    v_mov_b32 v17, 0
    v_mov_b32 v18, 1
    s_mov_b32 s64, 0
    s_nop 1
.L51:
    s_mov_b64 exec, 1
    ds_add_rtn_u32 v16, v17, v18 offset:536
    s_mov_b64 exec, -1
    s_waitcnt vmcnt(8)
    s_call_b64 s[84:85], .LpairB_92
    s_waitcnt lgkmcnt(0)
    v_readfirstlane_b32 s63, v16
    s_nop 0
    s_cmp_ge_u32 s63, 256
    s_nop 2
    s_cbranch_scc1 .L53
    s_mov_b32 s62, s63
    s_lshl_b32 s63, s63, 12
    buffer_load_dwordx4 v[92:95], v2, s[16:19], s63 offen offset:0 nt
    buffer_load_dwordx4 v[96:99], v2, s[16:19], s63 offen offset:1024 nt
    buffer_load_dwordx4 v[100:103], v2, s[16:19], s63 offen offset:2048 nt
    buffer_load_dwordx4 v[104:107], v2, s[16:19], s63 offen offset:3072 nt
    buffer_load_dwordx4 v[108:111], v2, s[20:23], s63 offen offset:0 nt
    buffer_load_dwordx4 v[112:115], v2, s[20:23], s63 offen offset:1024 nt
    buffer_load_dwordx4 v[116:119], v2, s[20:23], s63 offen offset:2048 nt
    buffer_load_dwordx4 v[120:123], v2, s[20:23], s63 offen offset:3072 nt
    s_mov_b64 exec, 1
    ds_add_rtn_u32 v16, v17, v18 offset:536
    s_mov_b64 exec, -1
    s_waitcnt vmcnt(8)
    s_call_b64 s[84:85], .LpairB_124
    s_waitcnt lgkmcnt(0)
    v_readfirstlane_b32 s63, v16
    s_nop 0
    s_cmp_ge_u32 s63, 256
    s_nop 2
    s_cbranch_scc1 .L54
    s_mov_b32 s62, s63
    s_lshl_b32 s63, s63, 12
    buffer_load_dwordx4 v[124:127], v2, s[16:19], s63 offen offset:0 nt
    buffer_load_dwordx4 v[128:131], v2, s[16:19], s63 offen offset:1024 nt
    buffer_load_dwordx4 v[132:135], v2, s[16:19], s63 offen offset:2048 nt
    buffer_load_dwordx4 v[136:139], v2, s[16:19], s63 offen offset:3072 nt
    buffer_load_dwordx4 v[140:143], v2, s[20:23], s63 offen offset:0 nt
    buffer_load_dwordx4 v[144:147], v2, s[20:23], s63 offen offset:1024 nt
    buffer_load_dwordx4 v[148:151], v2, s[20:23], s63 offen offset:2048 nt
    buffer_load_dwordx4 v[152:155], v2, s[20:23], s63 offen offset:3072 nt
    s_branch .L51
.L53:
    s_waitcnt vmcnt(0)
    s_call_b64 s[84:85], .LpairB_124
    s_branch .L52
.L54:
    s_waitcnt vmcnt(0)
    s_call_b64 s[84:85], .LpairB_92
.L52:
    s_call_b64 s[84:85], .LwcombB
    s_mov_b32 s88, 2
    s_mov_b32 s89, 589824
    s_mov_b32 s76, s36
    s_mov_b32 s77, s37
    s_mov_b32 s78, s38
    s_mov_b32 s79, 0x00020000
    s_mov_b32 s93, 1
    s_mov_b32 s92, 3407872
    s_mov_b32 s80, s24
    s_mov_b32 s81, s25
    s_mov_b32 s82, s26
    s_mov_b32 s83, 0x00020000
    s_cmp_ge_u32 s60, 4
    s_cbranch_scc1 .L57
    s_call_b64 s[84:85], .LcritB
    s_waitcnt lgkmcnt(0)
    v_mov_b32 v90, 0
    v_mov_b32 v91, 1
    s_mov_b64 exec, 1
    ds_add_u32 v90, v91 offset:512
    s_mov_b64 exec, -1
    s_add_u32 s96, s96, 4
.L59:
    ds_read_b32 v91, v90 offset:512
    s_waitcnt lgkmcnt(0)
    v_readfirstlane_b32 s71, v91
    s_nop 0
    s_cmp_lt_u32 s71, s96
    s_nop 2
    s_cbranch_scc1 .L59
    v_mov_b32 v91, 3
    ds_write_b32 v90, v91 offset:520
    s_mov_b32 s61, 20480
    buffer_load_dwordx4 v[92:95], v1, s[8:11], s61 offen offset:0 nt
    buffer_load_dwordx4 v[96:99], v1, s[8:11], s61 offen offset:1024 nt
    buffer_load_dwordx4 v[100:103], v1, s[8:11], s61 offen offset:2048 nt
    buffer_load_dwordx4 v[104:107], v1, s[8:11], s61 offen offset:3072 nt
    s_mov_b32 s61, 20480
    buffer_load_dwordx4 v[108:111], v1, s[12:15], s61 offen offset:0 nt
    buffer_load_dwordx4 v[112:115], v1, s[12:15], s61 offen offset:1024 nt
    buffer_load_dwordx4 v[116:119], v1, s[12:15], s61 offen offset:2048 nt
    buffer_load_dwordx4 v[120:123], v1, s[12:15], s61 offen offset:3072 nt
    s_mov_b32 s61, 24576
    buffer_load_dwordx4 v[124:127], v1, s[8:11], s61 offen offset:0 nt
    buffer_load_dwordx4 v[128:131], v1, s[8:11], s61 offen offset:1024 nt
    buffer_load_dwordx4 v[132:135], v1, s[8:11], s61 offen offset:2048 nt
    buffer_load_dwordx4 v[136:139], v1, s[8:11], s61 offen offset:3072 nt
    s_mov_b32 s61, 16384
    buffer_load_dwordx4 v[140:143], v1, s[12:15], s61 offen offset:0 nt
    buffer_load_dwordx4 v[144:147], v1, s[12:15], s61 offen offset:1024 nt
    buffer_load_dwordx4 v[148:151], v1, s[12:15], s61 offen offset:2048 nt
    buffer_load_dwordx4 v[152:155], v1, s[12:15], s61 offen offset:3072 nt
    s_branch .L58
.L57:
    s_barrier
    s_mov_b32 s61, 20480
    buffer_load_dwordx4 v[92:95], v1, s[8:11], s61 offen offset:0 nt
    buffer_load_dwordx4 v[96:99], v1, s[8:11], s61 offen offset:1024 nt
    buffer_load_dwordx4 v[100:103], v1, s[8:11], s61 offen offset:2048 nt
    buffer_load_dwordx4 v[104:107], v1, s[8:11], s61 offen offset:3072 nt
    s_mov_b32 s61, 20480
    buffer_load_dwordx4 v[108:111], v1, s[12:15], s61 offen offset:0 nt
    buffer_load_dwordx4 v[112:115], v1, s[12:15], s61 offen offset:1024 nt
    buffer_load_dwordx4 v[116:119], v1, s[12:15], s61 offen offset:2048 nt
    buffer_load_dwordx4 v[120:123], v1, s[12:15], s61 offen offset:3072 nt
    s_mov_b32 s61, 24576
    buffer_load_dwordx4 v[124:127], v1, s[8:11], s61 offen offset:0 nt
    buffer_load_dwordx4 v[128:131], v1, s[8:11], s61 offen offset:1024 nt
    buffer_load_dwordx4 v[132:135], v1, s[8:11], s61 offen offset:2048 nt
    buffer_load_dwordx4 v[136:139], v1, s[8:11], s61 offen offset:3072 nt
    s_mov_b32 s61, 16384
    buffer_load_dwordx4 v[140:143], v1, s[12:15], s61 offen offset:0 nt
    buffer_load_dwordx4 v[144:147], v1, s[12:15], s61 offen offset:1024 nt
    buffer_load_dwordx4 v[148:151], v1, s[12:15], s61 offen offset:2048 nt
    buffer_load_dwordx4 v[152:155], v1, s[12:15], s61 offen offset:3072 nt
    v_mov_b32 v90, 0
    s_nop 2
.L60:
    ds_read_b32 v91, v90 offset:520
    s_waitcnt lgkmcnt(0)
    v_readfirstlane_b32 s71, v91
    s_sleep 1
    s_cmp_lt_u32 s71, 3
    s_nop 2
    s_cbranch_scc1 .L60
.L58:
    v_and_b32 v84, 15, v0
    v_bfe_u32 v85, v0, 4, 2
    s_add_u32 s61, s99, 8192
    v_xor_b32 v86, v84, v85
    v_lshlrev_b32 v86, 4, v86
    v_lshl_add_u32 v53, v85, 8, v86
    v_add_u32 v53, s61, v53
    v_lshl_add_u32 v54, v84, 8, v86
    v_add_u32 v54, s61, v54
    v_lshlrev_b32 v86, 1, v85
    v_xor_b32 v86, v86, v84
    v_lshlrev_b32 v86, 4, v86
    v_lshl_add_u32 v55, v85, 8, v86
    v_lshrrev_b32 v86, 2, v84
    v_lshl_add_u32 v86, v85, 2, v86
    v_and_b32 v87, 7, v86
    v_lshlrev_b32 v87, 1, v87
    v_bfe_u32 v88, v84, 1, 1
    v_xor_b32 v87, v87, v88
    v_lshlrev_b32 v87, 4, v87
    v_lshl_add_u32 v87, v86, 8, v87
    v_and_b32 v88, 1, v84
    v_lshl_add_u32 v57, v88, 3, v87
    v_mov_b32 v4, 0
    v_mov_b32 v5, 0
    v_mov_b32 v6, 0
    v_mov_b32 v7, 0
    v_mov_b32 v8, 0
    v_mov_b32 v9, 0
    v_mov_b32 v10, 0
    v_mov_b32 v11, 0
    v_mov_b32 v12, 0
    v_mov_b32 v13, 0
    v_mov_b32 v14, 0
    v_mov_b32 v15, 0
    v_mov_b32 v16, 0
    v_mov_b32 v17, 0
    v_mov_b32 v18, 0
    v_mov_b32 v19, 0
    v_lshlrev_b32 v86, 8, v84
    v_lshl_add_u32 v86, v85, 4, v86
    s_mov_b32 s61, 0x000f000f
    s_mov_b32 exec_lo, s61
    s_mov_b32 exec_hi, s61
    ds_read_b128 v[4:7], v86 offset:2048
    ds_read_b128 v[8:11], v86 offset:2112
    ds_read_b128 v[12:15], v86 offset:2176
    ds_read_b128 v[16:19], v86 offset:2240
    s_mov_b64 exec, -1
    v_mov_b32 v20, 0
    v_mov_b32 v21, 0
    v_mov_b32 v22, 0
    v_mov_b32 v23, 0
    v_mov_b32 v24, 0
    v_mov_b32 v25, 0
    v_mov_b32 v26, 0
    v_mov_b32 v27, 0
    v_mov_b32 v28, 0
    v_mov_b32 v29, 0
    v_mov_b32 v30, 0
    v_mov_b32 v31, 0
    v_mov_b32 v32, 0
    v_mov_b32 v33, 0
    v_mov_b32 v34, 0
    v_mov_b32 v35, 0
    v_mov_b32 v36, 0
    v_mov_b32 v37, 0
    v_mov_b32 v38, 0
    v_mov_b32 v39, 0
    v_mov_b32 v40, 0
    v_mov_b32 v41, 0
    v_mov_b32 v42, 0
    v_mov_b32 v43, 0
    v_mov_b32 v44, 0
    v_mov_b32 v45, 0
    v_mov_b32 v46, 0
    v_mov_b32 v47, 0
    v_mov_b32 v48, 0
    v_mov_b32 v49, 0
    v_mov_b32 v50, 0
    v_mov_b32 v51, 0
    v_mov_b32 v52, 0xf149f2ca
    v_mov_b32 v56, 0
    s_waitcnt lgkmcnt(0)
    s_nop 1
    s_call_b64 s[84:85], .LqkA_156
    s_add_u32 s100, s101, 0
    s_call_b64 s[84:85], .LpvA
    s_mov_b32 s61, 24576
    buffer_load_dwordx4 v[156:159], v1, s[12:15], s61 offen offset:0 nt
    buffer_load_dwordx4 v[160:163], v1, s[12:15], s61 offen offset:1024 nt
    buffer_load_dwordx4 v[164:167], v1, s[12:15], s61 offen offset:2048 nt
    buffer_load_dwordx4 v[168:171], v1, s[12:15], s61 offen offset:3072 nt
    s_call_b64 s[84:85], .LqkA_172
    s_add_u32 s100, s101, 4096
    s_call_b64 s[84:85], .LpvA
    s_mov_b32 s61, 28672
    buffer_load_dwordx4 v[172:175], v1, s[8:11], s61 offen offset:0 nt
    buffer_load_dwordx4 v[176:179], v1, s[8:11], s61 offen offset:1024 nt
    buffer_load_dwordx4 v[180:183], v1, s[8:11], s61 offen offset:2048 nt
    buffer_load_dwordx4 v[184:187], v1, s[8:11], s61 offen offset:3072 nt
    s_call_b64 s[84:85], .LqkA_188
    s_add_u32 s100, s101, 8192
    s_call_b64 s[84:85], .LpvA
    s_mov_b32 s61, 28672
    buffer_load_dwordx4 v[188:191], v1, s[12:15], s61 offen offset:0 nt
    buffer_load_dwordx4 v[192:195], v1, s[12:15], s61 offen offset:1024 nt
    buffer_load_dwordx4 v[196:199], v1, s[12:15], s61 offen offset:2048 nt
    buffer_load_dwordx4 v[200:203], v1, s[12:15], s61 offen offset:3072 nt
    s_call_b64 s[84:85], .LqkA_204
    s_add_u32 s100, s99, 8192
    s_call_b64 s[84:85], .LvwA_236
    s_call_b64 s[84:85], .LqkA_220
    s_add_u32 s100, s99, 8192
    s_waitcnt vmcnt(12)
    s_call_b64 s[84:85], .LvwA_140
    s_sub_u32 s61, 1044480, s99
    buffer_load_dwordx4 v[220:223], v2, s[16:19], s61 offen offset:0 nt
    buffer_load_dwordx4 v[224:227], v2, s[16:19], s61 offen offset:1024 nt
    buffer_load_dwordx4 v[228:231], v2, s[16:19], s61 offen offset:2048 nt
    buffer_load_dwordx4 v[232:235], v2, s[16:19], s61 offen offset:3072 nt
    buffer_load_dwordx4 v[236:239], v2, s[20:23], s61 offen offset:0 nt
    buffer_load_dwordx4 v[240:243], v2, s[20:23], s61 offen offset:1024 nt
    buffer_load_dwordx4 v[244:247], v2, s[20:23], s61 offen offset:2048 nt
    buffer_load_dwordx4 v[248:251], v2, s[20:23], s61 offen offset:3072 nt
    s_call_b64 s[84:85], .LstK_92
    s_add_u32 s100, s99, 8192
    s_call_b64 s[84:85], .LvwA_108
    s_call_b64 s[84:85], .LstK_124
    s_add_u32 s100, s99, 8192
    s_waitcnt vmcnt(16)
    s_call_b64 s[84:85], .LvwA_156
    s_waitcnt vmcnt(12)
    s_call_b64 s[84:85], .LstK_172
    s_add_u32 s100, s99, 8192
    s_waitcnt vmcnt(8)
    s_call_b64 s[84:85], .LvwA_188
    s_sub_u32 s61, 1011712, s99
    buffer_load_dwordx4 v[156:159], v2, s[16:19], s61 offen offset:0 nt
    buffer_load_dwordx4 v[160:163], v2, s[16:19], s61 offen offset:1024 nt
    buffer_load_dwordx4 v[164:167], v2, s[16:19], s61 offen offset:2048 nt
    buffer_load_dwordx4 v[168:171], v2, s[16:19], s61 offen offset:3072 nt
    buffer_load_dwordx4 v[172:175], v2, s[20:23], s61 offen offset:0 nt
    buffer_load_dwordx4 v[176:179], v2, s[20:23], s61 offen offset:1024 nt
    buffer_load_dwordx4 v[180:183], v2, s[20:23], s61 offen offset:2048 nt
    buffer_load_dwordx4 v[184:187], v2, s[20:23], s61 offen offset:3072 nt
    s_sub_u32 s61, 978944, s99
    buffer_load_dwordx4 v[188:191], v2, s[16:19], s61 offen offset:0 nt
    buffer_load_dwordx4 v[192:195], v2, s[16:19], s61 offen offset:1024 nt
    buffer_load_dwordx4 v[196:199], v2, s[16:19], s61 offen offset:2048 nt
    buffer_load_dwordx4 v[200:203], v2, s[16:19], s61 offen offset:3072 nt
    buffer_load_dwordx4 v[204:207], v2, s[20:23], s61 offen offset:0 nt
    buffer_load_dwordx4 v[208:211], v2, s[20:23], s61 offen offset:1024 nt
    buffer_load_dwordx4 v[212:215], v2, s[20:23], s61 offen offset:2048 nt
    buffer_load_dwordx4 v[216:219], v2, s[20:23], s61 offen offset:3072 nt
    s_call_b64 s[84:85], .LwcombA
    s_mov_b32 s88, 3
    s_mov_b32 s89, 1114112
    s_mov_b32 s76, s28
    s_mov_b32 s77, s29
    s_mov_b32 s78, s30
    s_mov_b32 s79, 0x00020000
    s_mov_b32 s90, 4718592
    s_mov_b32 s91, 5308416
    s_mov_b32 s93, 0
    s_mov_b32 s92, 3670016
    s_mov_b32 s80, s32
    s_mov_b32 s81, s33
    s_mov_b32 s82, s34
    s_mov_b32 s83, 0x00020000
    s_cmp_ge_u32 s60, 4
    s_cbranch_scc1 .L61
    s_call_b64 s[84:85], .LcritA
    v_mov_b32 v90, 0
    v_mov_b32 v91, 40
    ds_write_b32 v90, v91 offset:536
    s_waitcnt lgkmcnt(0)
    v_mov_b32 v90, 0
    v_mov_b32 v91, 1
    s_mov_b64 exec, 1
    ds_add_u32 v90, v91 offset:512
    s_mov_b64 exec, -1
    s_add_u32 s96, s96, 4
.L63:
    ds_read_b32 v91, v90 offset:512
    s_waitcnt lgkmcnt(0)
    v_readfirstlane_b32 s71, v91
    s_nop 0
    s_cmp_lt_u32 s71, s96
    s_nop 2
    s_cbranch_scc1 .L63
    v_mov_b32 v91, 4
    ds_write_b32 v90, v91 offset:520
    s_sub_u32 s61, 946176, s99
    buffer_load_dwordx4 v[92:95], v2, s[16:19], s61 offen offset:0 nt
    buffer_load_dwordx4 v[96:99], v2, s[16:19], s61 offen offset:1024 nt
    buffer_load_dwordx4 v[100:103], v2, s[16:19], s61 offen offset:2048 nt
    buffer_load_dwordx4 v[104:107], v2, s[16:19], s61 offen offset:3072 nt
    buffer_load_dwordx4 v[108:111], v2, s[20:23], s61 offen offset:0 nt
    buffer_load_dwordx4 v[112:115], v2, s[20:23], s61 offen offset:1024 nt
    buffer_load_dwordx4 v[116:119], v2, s[20:23], s61 offen offset:2048 nt
    buffer_load_dwordx4 v[120:123], v2, s[20:23], s61 offen offset:3072 nt
    s_sub_u32 s61, 913408, s99
    buffer_load_dwordx4 v[124:127], v2, s[16:19], s61 offen offset:0 nt
    buffer_load_dwordx4 v[128:131], v2, s[16:19], s61 offen offset:1024 nt
    buffer_load_dwordx4 v[132:135], v2, s[16:19], s61 offen offset:2048 nt
    buffer_load_dwordx4 v[136:139], v2, s[16:19], s61 offen offset:3072 nt
    buffer_load_dwordx4 v[140:143], v2, s[20:23], s61 offen offset:0 nt
    buffer_load_dwordx4 v[144:147], v2, s[20:23], s61 offen offset:1024 nt
    buffer_load_dwordx4 v[148:151], v2, s[20:23], s61 offen offset:2048 nt
    buffer_load_dwordx4 v[152:155], v2, s[20:23], s61 offen offset:3072 nt
    s_branch .L62
.L61:
    s_barrier
    s_sub_u32 s61, 946176, s99
    buffer_load_dwordx4 v[92:95], v2, s[16:19], s61 offen offset:0 nt
    buffer_load_dwordx4 v[96:99], v2, s[16:19], s61 offen offset:1024 nt
    buffer_load_dwordx4 v[100:103], v2, s[16:19], s61 offen offset:2048 nt
    buffer_load_dwordx4 v[104:107], v2, s[16:19], s61 offen offset:3072 nt
    buffer_load_dwordx4 v[108:111], v2, s[20:23], s61 offen offset:0 nt
    buffer_load_dwordx4 v[112:115], v2, s[20:23], s61 offen offset:1024 nt
    buffer_load_dwordx4 v[116:119], v2, s[20:23], s61 offen offset:2048 nt
    buffer_load_dwordx4 v[120:123], v2, s[20:23], s61 offen offset:3072 nt
    s_sub_u32 s61, 913408, s99
    buffer_load_dwordx4 v[124:127], v2, s[16:19], s61 offen offset:0 nt
    buffer_load_dwordx4 v[128:131], v2, s[16:19], s61 offen offset:1024 nt
    buffer_load_dwordx4 v[132:135], v2, s[16:19], s61 offen offset:2048 nt
    buffer_load_dwordx4 v[136:139], v2, s[16:19], s61 offen offset:3072 nt
    buffer_load_dwordx4 v[140:143], v2, s[20:23], s61 offen offset:0 nt
    buffer_load_dwordx4 v[144:147], v2, s[20:23], s61 offen offset:1024 nt
    buffer_load_dwordx4 v[148:151], v2, s[20:23], s61 offen offset:2048 nt
    buffer_load_dwordx4 v[152:155], v2, s[20:23], s61 offen offset:3072 nt
    v_mov_b32 v90, 0
    s_nop 2
.L64:
    ds_read_b32 v91, v90 offset:520
    s_waitcnt lgkmcnt(0)
    v_readfirstlane_b32 s71, v91
    s_sleep 1
    s_cmp_lt_u32 s71, 4
    s_nop 2
    s_cbranch_scc1 .L64
.L62:
    v_and_b32 v84, 15, v0
    v_lshlrev_b32 v84, 4, v84
    ds_read_b128 v[4:7], v84 offset:2048
    v_mov_b32 v20, 0
    v_mov_b32 v21, 0
    v_mov_b32 v22, 0
    v_mov_b32 v23, 0
    v_mov_b32 v24, 0
    v_mov_b32 v25, 0
    v_mov_b32 v26, 0
    v_mov_b32 v27, 0
    v_mov_b32 v52, 0xf149f2ca
    v_mov_b32 v56, 0
    s_waitcnt lgkmcnt(0)
    s_waitcnt vmcnt(32)
    s_nop 0
    s_call_b64 s[84:85], .LpairB_220
    s_waitcnt vmcnt(24)
    s_call_b64 s[84:85], .LpairB_156
    s_waitcnt vmcnt(16)
    s_call_b64 s[84:85], .LpairB_188
    v_mov_b32 v17, 0
    v_mov_b32 v18, 1
    s_mov_b32 s64, 0
    s_nop 1
.L65:
    s_mov_b64 exec, 1
    ds_add_rtn_u32 v16, v17, v18 offset:536
    s_mov_b64 exec, -1
    s_waitcnt vmcnt(8)
    s_call_b64 s[84:85], .LpairB_92
    s_waitcnt lgkmcnt(0)
    v_readfirstlane_b32 s63, v16
    s_nop 0
    s_cmp_ge_u32 s63, 256
    s_nop 2
    s_cbranch_scc1 .L67
    s_mov_b32 s62, s63
    s_lshl_b32 s63, s63, 12
    s_sub_u32 s63, 1044480, s63
    buffer_load_dwordx4 v[92:95], v2, s[16:19], s63 offen offset:0 nt
    buffer_load_dwordx4 v[96:99], v2, s[16:19], s63 offen offset:1024 nt
    buffer_load_dwordx4 v[100:103], v2, s[16:19], s63 offen offset:2048 nt
    buffer_load_dwordx4 v[104:107], v2, s[16:19], s63 offen offset:3072 nt
    buffer_load_dwordx4 v[108:111], v2, s[20:23], s63 offen offset:0 nt
    buffer_load_dwordx4 v[112:115], v2, s[20:23], s63 offen offset:1024 nt
    buffer_load_dwordx4 v[116:119], v2, s[20:23], s63 offen offset:2048 nt
    buffer_load_dwordx4 v[120:123], v2, s[20:23], s63 offen offset:3072 nt
    s_mov_b64 exec, 1
    ds_add_rtn_u32 v16, v17, v18 offset:536
    s_mov_b64 exec, -1
    s_waitcnt vmcnt(8)
    s_call_b64 s[84:85], .LpairB_124
    s_waitcnt lgkmcnt(0)
    v_readfirstlane_b32 s63, v16
    s_nop 0
    s_cmp_ge_u32 s63, 256
    s_nop 2
    s_cbranch_scc1 .L68
    s_mov_b32 s62, s63
    s_lshl_b32 s63, s63, 12
    s_sub_u32 s63, 1044480, s63
    buffer_load_dwordx4 v[124:127], v2, s[16:19], s63 offen offset:0 nt
    buffer_load_dwordx4 v[128:131], v2, s[16:19], s63 offen offset:1024 nt
    buffer_load_dwordx4 v[132:135], v2, s[16:19], s63 offen offset:2048 nt
    buffer_load_dwordx4 v[136:139], v2, s[16:19], s63 offen offset:3072 nt
    buffer_load_dwordx4 v[140:143], v2, s[20:23], s63 offen offset:0 nt
    buffer_load_dwordx4 v[144:147], v2, s[20:23], s63 offen offset:1024 nt
    buffer_load_dwordx4 v[148:151], v2, s[20:23], s63 offen offset:2048 nt
    buffer_load_dwordx4 v[152:155], v2, s[20:23], s63 offen offset:3072 nt
    s_branch .L65
.L67:
    s_waitcnt vmcnt(0)
    s_call_b64 s[84:85], .LpairB_124
    s_branch .L66
.L68:
    s_waitcnt vmcnt(0)
    s_call_b64 s[84:85], .LpairB_92
.L66:
    s_call_b64 s[84:85], .LwcombB
    s_mov_b32 s88, 4
    s_mov_b32 s89, 1638400
    s_mov_b32 s76, s36
    s_mov_b32 s77, s37
    s_mov_b32 s78, s38
    s_mov_b32 s79, 0x00020000
    s_mov_b32 s93, 1
    s_mov_b32 s92, 3670016
    s_mov_b32 s80, s24
    s_mov_b32 s81, s25
    s_mov_b32 s82, s26
    s_mov_b32 s83, 0x00020000
    s_cmp_ge_u32 s60, 4
    s_cbranch_scc1 .L71
    s_call_b64 s[84:85], .LcritB
    s_branch .Lend
.L71:
    s_barrier
    s_branch .Lend
.Lend:
    s_endpgm
.section .rodata,"a"
.p2align 6
.amdhsa_kernel interleave_layers__gqa_block_cached__mha_block_cached__decode_kernel
  .amdhsa_next_free_vgpr 256
  .amdhsa_next_free_sgpr 102
  .amdhsa_accum_offset 256
  .amdhsa_group_segment_fixed_size 0
  .amdhsa_kernarg_size 104
  .amdhsa_user_sgpr_count 2
  .amdhsa_user_sgpr_kernarg_segment_ptr 1
  .amdhsa_system_sgpr_workgroup_id_x 1
  .amdhsa_float_denorm_mode_32 3
  .amdhsa_float_denorm_mode_16_64 3
.end_amdhsa_kernel
```
